```python
import torch

def _softmax(x, axis=-1):
    return torch.softmax(x, dim=axis)
def _gelu(x):
    return torch.nn.functional.gelu(x, approximate="tanh")
def _silu(x):
    return torch.nn.functional.silu(x)
def _sigmoid(x):
    return torch.sigmoid(x)
def _layernorm(x, axis=-1, eps=1e-5):
    m = x.mean(dim=axis, keepdim=True)
    v = x.var(dim=axis, keepdim=True, unbiased=False)
    return (x - m) / torch.sqrt(v + eps)
def _scatter_add(tgt, idx, src, axis=0):
    return tgt.clone().index_add_(axis, idx, src)
def _segment_sum(src, seg, n):
    out = torch.zeros((n,) + src.shape[1:], dtype=src.dtype)
    return out.index_add_(0, seg, src)
def _pad(x, pw):
    flat = tuple(v for pair in reversed(pw) for v in pair)
    return torch.nn.functional.pad(x, flat)

kernel_name = 'sequential_preLN__sliding_block_cached__glu_gated_glu__decode'

def setup_inputs():

    _w = (lambda a: (lambda t: t.to(torch.bfloat16) if t.is_floating_point() else t)(torch.as_tensor(a)))
    def _A_setup():
        B, Sq, D = 2, 1, 512
        Hq, Hkv, Sk, Dh = 32, 8, 32768, 128
        assert Hq % Hkv == 0, (Hq, Hkv)
        return {
            "x": _w((lambda *s: torch.randn(*s, dtype=torch.bfloat16) * 0.05)(B, Sq, D)),
            "k_cache": _w((lambda *s: torch.randn(*s, dtype=torch.bfloat16) * 3.2)(B, Hkv, Sk, Dh)),
            "v_cache": _w((lambda *s: torch.randn(*s, dtype=torch.bfloat16) * 0.4)(B, Hkv, Sk, Dh)),
            "wq": _w((lambda *s: torch.randn(*s, dtype=torch.bfloat16) * 3.2)(D, Hq * Dh) * (D ** -0.5)),
            "wo": _w((lambda *s: torch.randn(*s, dtype=torch.bfloat16) * 0.4)(Hq * Dh, D) * ((Hq * Dh) ** -0.5)),
        }
    _A_in = _A_setup()

    def _B_setup():
        B, S, D, F = 2, 1, 512, 1792
        return {
            "x": _w((lambda *s: torch.randn(*s, dtype=torch.bfloat16) * 0.05)(B, S, D)),
            "w_gate": _w((lambda *s: torch.randn(*s, dtype=torch.bfloat16) * 0.1)(D, F)),
            "w_up": _w((lambda *s: torch.randn(*s, dtype=torch.bfloat16) * 0.05)(D, F)),
            "w_down": _w((lambda *s: torch.randn(*s, dtype=torch.bfloat16) * 0.05)(F, D)),
        }
    _B_in = _B_setup()

    return {
        "A_x": _A_in["x"],
        "A_k_cache": _A_in["k_cache"],
        "A_v_cache": _A_in["v_cache"],
        "A_wq": _A_in["wq"],
        "A_wo": _A_in["wo"],
        "B_x": _B_in["x"],
        "B_w_gate": _B_in["w_gate"],
        "B_w_up": _B_in["w_up"],
        "B_w_down": _B_in["w_down"],
    }

def reference(A_x, A_k_cache, A_v_cache, A_wq, A_wo, B_x, B_w_gate, B_w_up, B_w_down):
    def _A_ref(x, k_cache, v_cache, wq, wo):
        B, Sq, D = x.shape
        Hq, Dh = 32, 128
        Hkv, Sk = k_cache.shape[1], k_cache.shape[2]
        W = min(4096, max(256, Sk // 4))
        rep = Hq // Hkv
        q = (lambda x, *d: x.permute(*d))((x @ wq).reshape(B, Sq, Hq, Dh), 0, 2, 1, 3)
        k = (lambda x, n, axis: torch.repeat_interleave(x, n, dim=axis))(k_cache[:, :, Sk - W:, :], rep, axis=1)
        v = (lambda x, n, axis: torch.repeat_interleave(x, n, dim=axis))(v_cache[:, :, Sk - W:, :], rep, axis=1)
        scores = torch.einsum("bhqd,bhkd->bhqk", q, k) * (Dh ** -0.5)
        p = _softmax(scores, axis=-1)
        o = torch.einsum("bhqk,bhkd->bhqd", p, v)
        return (lambda x, *d: x.permute(*d))(o, 0, 2, 1, 3).reshape(B, Sq, Hq * Dh) @ wo

    def _B_ref(x, w_gate, w_up, w_down):
        g = torch.einsum("bsd,df->bsf", x, w_gate)
        u = torch.einsum("bsd,df->bsf", x, w_up)
        h = _sigmoid(g) * u
        return torch.einsum("bsf,fd->bsd", h, w_down)

    x = A_x
    h = x + _A_ref(_layernorm(x, axis=-1), A_k_cache, A_v_cache, A_wq, A_wo)
    h2 = h + _B_ref(_layernorm(h, axis=-1), B_w_gate, B_w_up, B_w_down)
    return h2
```

```asm
; @launch kernel=k1_qproj_kernel grid=(128,1,1) block=(256,1,1) lds=8192
; @launch kernel=k2_attn_kernel grid=(256,1,1) block=(256,1,1) lds=37120
; @launch kernel=k3_oproj_kernel grid=(256,1,1) block=(256,1,1) lds=8192
; @launch kernel=k4_mlp_kernel grid=(112,1,1) block=(256,1,1) lds=8192
; @launch kernel=k5_final_kernel grid=(16,1,1) block=(256,1,1) lds=2048
.amdgcn_target "amdgcn-amd-amdhsa--gfx950"
.text
.globl k1_qproj_kernel
.p2align 8
.type k1_qproj_kernel,@function
k1_qproj_kernel:
    s_cmp_ge_u32 s2, 128
    s_cbranch_scc1 k1_qproj_kernel_end
    s_load_dwordx2 s[4:5], s[0:1], 0
    s_load_dwordx2 s[6:7], s[0:1], 24
    s_load_dwordx2 s[8:9], s[0:1], 88
    v_and_b32 v1, 63, v0
    v_lshrrev_b32 v2, 6, v0
    v_and_b32 v3, 3, v0
    v_lshrrev_b32 v4, 2, v0
    s_lshl_b32 s3, s2, 6
    v_lshlrev_b32 v5, 13, v4
    v_lshl_add_u32 v5, v3, 4, v5
    v_add_u32 v5, s3, v5
    v_and_b32 v6, 1, v2
    v_lshlrev_b32 v7, 10, v6
    v_lshl_add_u32 v7, v1, 4, v7
    s_waitcnt lgkmcnt(0)
    global_load_dwordx4 v[8:11], v7, s[4:5]
    global_load_dwordx4 v[32:35], v5, s[6:7]
    v_add_u32 v5, 0x80000, v5
    global_load_dwordx4 v[36:39], v5, s[6:7]
    v_add_u32 v5, 0x80000, v5
    global_load_dwordx4 v[40:43], v5, s[6:7]
    v_add_u32 v5, 0x80000, v5
    global_load_dwordx4 v[44:47], v5, s[6:7]
    v_add_u32 v5, 0x80000, v5
    global_load_dwordx4 v[48:51], v5, s[6:7]
    v_add_u32 v5, 0x80000, v5
    global_load_dwordx4 v[52:55], v5, s[6:7]
    v_add_u32 v5, 0x80000, v5
    global_load_dwordx4 v[56:59], v5, s[6:7]
    v_add_u32 v5, 0x80000, v5
    global_load_dwordx4 v[60:63], v5, s[6:7]
    s_waitcnt vmcnt(8)
    v_lshlrev_b32 v12, 16, v8
    v_and_b32 v13, 0xffff0000, v8
    v_lshlrev_b32 v14, 16, v9
    v_and_b32 v15, 0xffff0000, v9
    v_lshlrev_b32 v16, 16, v10
    v_and_b32 v17, 0xffff0000, v10
    v_lshlrev_b32 v18, 16, v11
    v_and_b32 v19, 0xffff0000, v11
    v_add_f32 v20, v12, v13
    v_add_f32 v20, v20, v14
    v_add_f32 v20, v20, v15
    v_add_f32 v20, v20, v16
    v_add_f32 v20, v20, v17
    v_add_f32 v20, v20, v18
    v_add_f32 v20, v20, v19
    s_nop 1
    v_add_f32_dpp v20, v20, v20 row_ror:1 row_mask:0xf bank_mask:0xf
    s_nop 1
    v_add_f32_dpp v20, v20, v20 row_ror:2 row_mask:0xf bank_mask:0xf
    s_nop 1
    v_add_f32_dpp v20, v20, v20 row_ror:4 row_mask:0xf bank_mask:0xf
    s_nop 1
    v_add_f32_dpp v20, v20, v20 row_ror:8 row_mask:0xf bank_mask:0xf
    v_mov_b32 v21, v20
    s_nop 1
    v_permlane16_swap_b32 v20, v21
    s_nop 1
    v_add_f32 v20, v20, v21
    v_mov_b32 v21, v20
    s_nop 1
    v_permlane32_swap_b32 v20, v21
    s_nop 1
    v_add_f32 v20, v20, v21
    v_mul_f32 v20, 0x3b000000, v20
    v_sub_f32 v21, v12, v20
    v_mul_f32 v22, v21, v21
    v_sub_f32 v21, v13, v20
    v_fmac_f32 v22, v21, v21
    v_sub_f32 v21, v14, v20
    v_fmac_f32 v22, v21, v21
    v_sub_f32 v21, v15, v20
    v_fmac_f32 v22, v21, v21
    v_sub_f32 v21, v16, v20
    v_fmac_f32 v22, v21, v21
    v_sub_f32 v21, v17, v20
    v_fmac_f32 v22, v21, v21
    v_sub_f32 v21, v18, v20
    v_fmac_f32 v22, v21, v21
    v_sub_f32 v21, v19, v20
    v_fmac_f32 v22, v21, v21
    s_nop 1
    v_add_f32_dpp v22, v22, v22 row_ror:1 row_mask:0xf bank_mask:0xf
    s_nop 1
    v_add_f32_dpp v22, v22, v22 row_ror:2 row_mask:0xf bank_mask:0xf
    s_nop 1
    v_add_f32_dpp v22, v22, v22 row_ror:4 row_mask:0xf bank_mask:0xf
    s_nop 1
    v_add_f32_dpp v22, v22, v22 row_ror:8 row_mask:0xf bank_mask:0xf
    v_mov_b32 v21, v22
    s_nop 1
    v_permlane16_swap_b32 v22, v21
    s_nop 1
    v_add_f32 v22, v22, v21
    v_mov_b32 v21, v22
    s_nop 1
    v_permlane32_swap_b32 v22, v21
    s_nop 1
    v_add_f32 v22, v22, v21
    v_mul_f32 v22, 0x3b000000, v22
    v_cvt_pk_bf16_f32 v22, v22, v22
    v_lshlrev_b32 v22, 16, v22
    v_add_f32 v22, 0x3727c5ac, v22
    v_cvt_pk_bf16_f32 v22, v22, v22
    v_lshlrev_b32 v22, 16, v22
    v_sqrt_f32 v22, v22
    s_nop 0
    v_cvt_pk_bf16_f32 v22, v22, v22
    v_lshlrev_b32 v22, 16, v22
    v_rcp_f32 v22, v22
    v_cvt_pk_bf16_f32 v20, v20, v20
    v_lshlrev_b32 v20, 16, v20
    v_sub_f32 v12, v12, v20
    v_cvt_pk_bf16_f32 v12, v12, v12
    v_lshlrev_b32 v12, 16, v12
    v_mul_f32 v12, v12, v22
    v_cvt_pk_bf16_f32 v12, v12, v12
    v_lshlrev_b32 v12, 16, v12
    v_sub_f32 v13, v13, v20
    v_cvt_pk_bf16_f32 v13, v13, v13
    v_lshlrev_b32 v13, 16, v13
    v_mul_f32 v13, v13, v22
    v_cvt_pk_bf16_f32 v13, v13, v13
    v_lshlrev_b32 v13, 16, v13
    v_sub_f32 v14, v14, v20
    v_cvt_pk_bf16_f32 v14, v14, v14
    v_lshlrev_b32 v14, 16, v14
    v_mul_f32 v14, v14, v22
    v_cvt_pk_bf16_f32 v14, v14, v14
    v_lshlrev_b32 v14, 16, v14
    v_sub_f32 v15, v15, v20
    v_cvt_pk_bf16_f32 v15, v15, v15
    v_lshlrev_b32 v15, 16, v15
    v_mul_f32 v15, v15, v22
    v_cvt_pk_bf16_f32 v15, v15, v15
    v_lshlrev_b32 v15, 16, v15
    v_sub_f32 v16, v16, v20
    v_cvt_pk_bf16_f32 v16, v16, v16
    v_lshlrev_b32 v16, 16, v16
    v_mul_f32 v16, v16, v22
    v_cvt_pk_bf16_f32 v16, v16, v16
    v_lshlrev_b32 v16, 16, v16
    v_sub_f32 v17, v17, v20
    v_cvt_pk_bf16_f32 v17, v17, v17
    v_lshlrev_b32 v17, 16, v17
    v_mul_f32 v17, v17, v22
    v_cvt_pk_bf16_f32 v17, v17, v17
    v_lshlrev_b32 v17, 16, v17
    v_sub_f32 v18, v18, v20
    v_cvt_pk_bf16_f32 v18, v18, v18
    v_lshlrev_b32 v18, 16, v18
    v_mul_f32 v18, v18, v22
    v_cvt_pk_bf16_f32 v18, v18, v18
    v_lshlrev_b32 v18, 16, v18
    v_sub_f32 v19, v19, v20
    v_cvt_pk_bf16_f32 v19, v19, v19
    v_lshlrev_b32 v19, 16, v19
    v_mul_f32 v19, v19, v22
    v_cvt_pk_bf16_f32 v19, v19, v19
    v_lshlrev_b32 v19, 16, v19
    v_lshlrev_b32 v23, 6, v1
    v_lshl_add_u32 v23, v6, 2, v23
    ds_write_b32 v23, v12 offset:0
    ds_write_b32 v23, v13 offset:8
    ds_write_b32 v23, v14 offset:16
    ds_write_b32 v23, v15 offset:24
    ds_write_b32 v23, v16 offset:32
    ds_write_b32 v23, v17 offset:40
    ds_write_b32 v23, v18 offset:48
    ds_write_b32 v23, v19 offset:56
    s_waitcnt lgkmcnt(0)
    s_barrier
    v_lshlrev_b32 v23, 3, v4
    ds_read_b64 v[64:65], v23 offset:0
    ds_read_b64 v[66:67], v23 offset:512
    ds_read_b64 v[68:69], v23 offset:1024
    ds_read_b64 v[70:71], v23 offset:1536
    ds_read_b64 v[72:73], v23 offset:2048
    ds_read_b64 v[74:75], v23 offset:2560
    ds_read_b64 v[76:77], v23 offset:3072
    ds_read_b64 v[78:79], v23 offset:3584
    v_mov_b32 v80, 0
    v_mov_b32 v81, 0
    v_mov_b32 v82, 0
    v_mov_b32 v83, 0
    v_mov_b32 v84, 0
    v_mov_b32 v85, 0
    v_mov_b32 v86, 0
    v_mov_b32 v87, 0
    v_mov_b32 v88, 0
    v_mov_b32 v89, 0
    v_mov_b32 v90, 0
    v_mov_b32 v91, 0
    v_mov_b32 v92, 0
    v_mov_b32 v93, 0
    v_mov_b32 v94, 0
    v_mov_b32 v95, 0
    s_waitcnt lgkmcnt(0)
    s_waitcnt vmcnt(7)
    v_lshlrev_b32 v24, 16, v32
    v_and_b32 v25, 0xffff0000, v32
    v_fmac_f32 v80, v64, v24
    v_fmac_f32 v81, v64, v25
    v_fmac_f32 v88, v65, v24
    v_fmac_f32 v89, v65, v25
    v_lshlrev_b32 v24, 16, v33
    v_and_b32 v25, 0xffff0000, v33
    v_fmac_f32 v82, v64, v24
    v_fmac_f32 v83, v64, v25
    v_fmac_f32 v90, v65, v24
    v_fmac_f32 v91, v65, v25
    v_lshlrev_b32 v24, 16, v34
    v_and_b32 v25, 0xffff0000, v34
    v_fmac_f32 v84, v64, v24
    v_fmac_f32 v85, v64, v25
    v_fmac_f32 v92, v65, v24
    v_fmac_f32 v93, v65, v25
    v_lshlrev_b32 v24, 16, v35
    v_and_b32 v25, 0xffff0000, v35
    v_fmac_f32 v86, v64, v24
    v_fmac_f32 v87, v64, v25
    v_fmac_f32 v94, v65, v24
    v_fmac_f32 v95, v65, v25
    s_waitcnt vmcnt(6)
    v_lshlrev_b32 v24, 16, v36
    v_and_b32 v25, 0xffff0000, v36
    v_fmac_f32 v80, v66, v24
    v_fmac_f32 v81, v66, v25
    v_fmac_f32 v88, v67, v24
    v_fmac_f32 v89, v67, v25
    v_lshlrev_b32 v24, 16, v37
    v_and_b32 v25, 0xffff0000, v37
    v_fmac_f32 v82, v66, v24
    v_fmac_f32 v83, v66, v25
    v_fmac_f32 v90, v67, v24
    v_fmac_f32 v91, v67, v25
    v_lshlrev_b32 v24, 16, v38
    v_and_b32 v25, 0xffff0000, v38
    v_fmac_f32 v84, v66, v24
    v_fmac_f32 v85, v66, v25
    v_fmac_f32 v92, v67, v24
    v_fmac_f32 v93, v67, v25
    v_lshlrev_b32 v24, 16, v39
    v_and_b32 v25, 0xffff0000, v39
    v_fmac_f32 v86, v66, v24
    v_fmac_f32 v87, v66, v25
    v_fmac_f32 v94, v67, v24
    v_fmac_f32 v95, v67, v25
    s_waitcnt vmcnt(5)
    v_lshlrev_b32 v24, 16, v40
    v_and_b32 v25, 0xffff0000, v40
    v_fmac_f32 v80, v68, v24
    v_fmac_f32 v81, v68, v25
    v_fmac_f32 v88, v69, v24
    v_fmac_f32 v89, v69, v25
    v_lshlrev_b32 v24, 16, v41
    v_and_b32 v25, 0xffff0000, v41
    v_fmac_f32 v82, v68, v24
    v_fmac_f32 v83, v68, v25
    v_fmac_f32 v90, v69, v24
    v_fmac_f32 v91, v69, v25
    v_lshlrev_b32 v24, 16, v42
    v_and_b32 v25, 0xffff0000, v42
    v_fmac_f32 v84, v68, v24
    v_fmac_f32 v85, v68, v25
    v_fmac_f32 v92, v69, v24
    v_fmac_f32 v93, v69, v25
    v_lshlrev_b32 v24, 16, v43
    v_and_b32 v25, 0xffff0000, v43
    v_fmac_f32 v86, v68, v24
    v_fmac_f32 v87, v68, v25
    v_fmac_f32 v94, v69, v24
    v_fmac_f32 v95, v69, v25
    s_waitcnt vmcnt(4)
    v_lshlrev_b32 v24, 16, v44
    v_and_b32 v25, 0xffff0000, v44
    v_fmac_f32 v80, v70, v24
    v_fmac_f32 v81, v70, v25
    v_fmac_f32 v88, v71, v24
    v_fmac_f32 v89, v71, v25
    v_lshlrev_b32 v24, 16, v45
    v_and_b32 v25, 0xffff0000, v45
    v_fmac_f32 v82, v70, v24
    v_fmac_f32 v83, v70, v25
    v_fmac_f32 v90, v71, v24
    v_fmac_f32 v91, v71, v25
    v_lshlrev_b32 v24, 16, v46
    v_and_b32 v25, 0xffff0000, v46
    v_fmac_f32 v84, v70, v24
    v_fmac_f32 v85, v70, v25
    v_fmac_f32 v92, v71, v24
    v_fmac_f32 v93, v71, v25
    v_lshlrev_b32 v24, 16, v47
    v_and_b32 v25, 0xffff0000, v47
    v_fmac_f32 v86, v70, v24
    v_fmac_f32 v87, v70, v25
    v_fmac_f32 v94, v71, v24
    v_fmac_f32 v95, v71, v25
    s_waitcnt vmcnt(3)
    v_lshlrev_b32 v24, 16, v48
    v_and_b32 v25, 0xffff0000, v48
    v_fmac_f32 v80, v72, v24
    v_fmac_f32 v81, v72, v25
    v_fmac_f32 v88, v73, v24
    v_fmac_f32 v89, v73, v25
    v_lshlrev_b32 v24, 16, v49
    v_and_b32 v25, 0xffff0000, v49
    v_fmac_f32 v82, v72, v24
    v_fmac_f32 v83, v72, v25
    v_fmac_f32 v90, v73, v24
    v_fmac_f32 v91, v73, v25
    v_lshlrev_b32 v24, 16, v50
    v_and_b32 v25, 0xffff0000, v50
    v_fmac_f32 v84, v72, v24
    v_fmac_f32 v85, v72, v25
    v_fmac_f32 v92, v73, v24
    v_fmac_f32 v93, v73, v25
    v_lshlrev_b32 v24, 16, v51
    v_and_b32 v25, 0xffff0000, v51
    v_fmac_f32 v86, v72, v24
    v_fmac_f32 v87, v72, v25
    v_fmac_f32 v94, v73, v24
    v_fmac_f32 v95, v73, v25
    s_waitcnt vmcnt(2)
    v_lshlrev_b32 v24, 16, v52
    v_and_b32 v25, 0xffff0000, v52
    v_fmac_f32 v80, v74, v24
    v_fmac_f32 v81, v74, v25
    v_fmac_f32 v88, v75, v24
    v_fmac_f32 v89, v75, v25
    v_lshlrev_b32 v24, 16, v53
    v_and_b32 v25, 0xffff0000, v53
    v_fmac_f32 v82, v74, v24
    v_fmac_f32 v83, v74, v25
    v_fmac_f32 v90, v75, v24
    v_fmac_f32 v91, v75, v25
    v_lshlrev_b32 v24, 16, v54
    v_and_b32 v25, 0xffff0000, v54
    v_fmac_f32 v84, v74, v24
    v_fmac_f32 v85, v74, v25
    v_fmac_f32 v92, v75, v24
    v_fmac_f32 v93, v75, v25
    v_lshlrev_b32 v24, 16, v55
    v_and_b32 v25, 0xffff0000, v55
    v_fmac_f32 v86, v74, v24
    v_fmac_f32 v87, v74, v25
    v_fmac_f32 v94, v75, v24
    v_fmac_f32 v95, v75, v25
    s_waitcnt vmcnt(1)
    v_lshlrev_b32 v24, 16, v56
    v_and_b32 v25, 0xffff0000, v56
    v_fmac_f32 v80, v76, v24
    v_fmac_f32 v81, v76, v25
    v_fmac_f32 v88, v77, v24
    v_fmac_f32 v89, v77, v25
    v_lshlrev_b32 v24, 16, v57
    v_and_b32 v25, 0xffff0000, v57
    v_fmac_f32 v82, v76, v24
    v_fmac_f32 v83, v76, v25
    v_fmac_f32 v90, v77, v24
    v_fmac_f32 v91, v77, v25
    v_lshlrev_b32 v24, 16, v58
    v_and_b32 v25, 0xffff0000, v58
    v_fmac_f32 v84, v76, v24
    v_fmac_f32 v85, v76, v25
    v_fmac_f32 v92, v77, v24
    v_fmac_f32 v93, v77, v25
    v_lshlrev_b32 v24, 16, v59
    v_and_b32 v25, 0xffff0000, v59
    v_fmac_f32 v86, v76, v24
    v_fmac_f32 v87, v76, v25
    v_fmac_f32 v94, v77, v24
    v_fmac_f32 v95, v77, v25
    s_waitcnt vmcnt(0)
    v_lshlrev_b32 v24, 16, v60
    v_and_b32 v25, 0xffff0000, v60
    v_fmac_f32 v80, v78, v24
    v_fmac_f32 v81, v78, v25
    v_fmac_f32 v88, v79, v24
    v_fmac_f32 v89, v79, v25
    v_lshlrev_b32 v24, 16, v61
    v_and_b32 v25, 0xffff0000, v61
    v_fmac_f32 v82, v78, v24
    v_fmac_f32 v83, v78, v25
    v_fmac_f32 v90, v79, v24
    v_fmac_f32 v91, v79, v25
    v_lshlrev_b32 v24, 16, v62
    v_and_b32 v25, 0xffff0000, v62
    v_fmac_f32 v84, v78, v24
    v_fmac_f32 v85, v78, v25
    v_fmac_f32 v92, v79, v24
    v_fmac_f32 v93, v79, v25
    v_lshlrev_b32 v24, 16, v63
    v_and_b32 v25, 0xffff0000, v63
    v_fmac_f32 v86, v78, v24
    v_fmac_f32 v87, v78, v25
    v_fmac_f32 v94, v79, v24
    v_fmac_f32 v95, v79, v25
    s_nop 1
    v_add_f32_dpp v80, v80, v80 row_ror:4 row_mask:0xf bank_mask:0xf
    v_add_f32_dpp v81, v81, v81 row_ror:4 row_mask:0xf bank_mask:0xf
    v_add_f32_dpp v82, v82, v82 row_ror:4 row_mask:0xf bank_mask:0xf
    v_add_f32_dpp v83, v83, v83 row_ror:4 row_mask:0xf bank_mask:0xf
    v_add_f32_dpp v84, v84, v84 row_ror:4 row_mask:0xf bank_mask:0xf
    v_add_f32_dpp v85, v85, v85 row_ror:4 row_mask:0xf bank_mask:0xf
    v_add_f32_dpp v86, v86, v86 row_ror:4 row_mask:0xf bank_mask:0xf
    v_add_f32_dpp v87, v87, v87 row_ror:4 row_mask:0xf bank_mask:0xf
    v_add_f32_dpp v88, v88, v88 row_ror:4 row_mask:0xf bank_mask:0xf
    v_add_f32_dpp v89, v89, v89 row_ror:4 row_mask:0xf bank_mask:0xf
    v_add_f32_dpp v90, v90, v90 row_ror:4 row_mask:0xf bank_mask:0xf
    v_add_f32_dpp v91, v91, v91 row_ror:4 row_mask:0xf bank_mask:0xf
    v_add_f32_dpp v92, v92, v92 row_ror:4 row_mask:0xf bank_mask:0xf
    v_add_f32_dpp v93, v93, v93 row_ror:4 row_mask:0xf bank_mask:0xf
    v_add_f32_dpp v94, v94, v94 row_ror:4 row_mask:0xf bank_mask:0xf
    v_add_f32_dpp v95, v95, v95 row_ror:4 row_mask:0xf bank_mask:0xf
    s_nop 1
    v_add_f32_dpp v80, v80, v80 row_ror:8 row_mask:0xf bank_mask:0xf
    v_add_f32_dpp v81, v81, v81 row_ror:8 row_mask:0xf bank_mask:0xf
    v_add_f32_dpp v82, v82, v82 row_ror:8 row_mask:0xf bank_mask:0xf
    v_add_f32_dpp v83, v83, v83 row_ror:8 row_mask:0xf bank_mask:0xf
    v_add_f32_dpp v84, v84, v84 row_ror:8 row_mask:0xf bank_mask:0xf
    v_add_f32_dpp v85, v85, v85 row_ror:8 row_mask:0xf bank_mask:0xf
    v_add_f32_dpp v86, v86, v86 row_ror:8 row_mask:0xf bank_mask:0xf
    v_add_f32_dpp v87, v87, v87 row_ror:8 row_mask:0xf bank_mask:0xf
    v_add_f32_dpp v88, v88, v88 row_ror:8 row_mask:0xf bank_mask:0xf
    v_add_f32_dpp v89, v89, v89 row_ror:8 row_mask:0xf bank_mask:0xf
    v_add_f32_dpp v90, v90, v90 row_ror:8 row_mask:0xf bank_mask:0xf
    v_add_f32_dpp v91, v91, v91 row_ror:8 row_mask:0xf bank_mask:0xf
    v_add_f32_dpp v92, v92, v92 row_ror:8 row_mask:0xf bank_mask:0xf
    v_add_f32_dpp v93, v93, v93 row_ror:8 row_mask:0xf bank_mask:0xf
    v_add_f32_dpp v94, v94, v94 row_ror:8 row_mask:0xf bank_mask:0xf
    v_add_f32_dpp v95, v95, v95 row_ror:8 row_mask:0xf bank_mask:0xf
    v_mov_b32 v24, v80
    s_nop 1
    v_permlane16_swap_b32 v80, v24
    s_nop 1
    v_add_f32 v80, v80, v24
    v_mov_b32 v24, v81
    s_nop 1
    v_permlane16_swap_b32 v81, v24
    s_nop 1
    v_add_f32 v81, v81, v24
    v_mov_b32 v24, v82
    s_nop 1
    v_permlane16_swap_b32 v82, v24
    s_nop 1
    v_add_f32 v82, v82, v24
    v_mov_b32 v24, v83
    s_nop 1
    v_permlane16_swap_b32 v83, v24
    s_nop 1
    v_add_f32 v83, v83, v24
    v_mov_b32 v24, v84
    s_nop 1
    v_permlane16_swap_b32 v84, v24
    s_nop 1
    v_add_f32 v84, v84, v24
    v_mov_b32 v24, v85
    s_nop 1
    v_permlane16_swap_b32 v85, v24
    s_nop 1
    v_add_f32 v85, v85, v24
    v_mov_b32 v24, v86
    s_nop 1
    v_permlane16_swap_b32 v86, v24
    s_nop 1
    v_add_f32 v86, v86, v24
    v_mov_b32 v24, v87
    s_nop 1
    v_permlane16_swap_b32 v87, v24
    s_nop 1
    v_add_f32 v87, v87, v24
    v_mov_b32 v24, v88
    s_nop 1
    v_permlane16_swap_b32 v88, v24
    s_nop 1
    v_add_f32 v88, v88, v24
    v_mov_b32 v24, v89
    s_nop 1
    v_permlane16_swap_b32 v89, v24
    s_nop 1
    v_add_f32 v89, v89, v24
    v_mov_b32 v24, v90
    s_nop 1
    v_permlane16_swap_b32 v90, v24
    s_nop 1
    v_add_f32 v90, v90, v24
    v_mov_b32 v24, v91
    s_nop 1
    v_permlane16_swap_b32 v91, v24
    s_nop 1
    v_add_f32 v91, v91, v24
    v_mov_b32 v24, v92
    s_nop 1
    v_permlane16_swap_b32 v92, v24
    s_nop 1
    v_add_f32 v92, v92, v24
    v_mov_b32 v24, v93
    s_nop 1
    v_permlane16_swap_b32 v93, v24
    s_nop 1
    v_add_f32 v93, v93, v24
    v_mov_b32 v24, v94
    s_nop 1
    v_permlane16_swap_b32 v94, v24
    s_nop 1
    v_add_f32 v94, v94, v24
    v_mov_b32 v24, v95
    s_nop 1
    v_permlane16_swap_b32 v95, v24
    s_nop 1
    v_add_f32 v95, v95, v24
    v_mov_b32 v24, v80
    s_nop 1
    v_permlane32_swap_b32 v80, v24
    s_nop 1
    v_add_f32 v80, v80, v24
    v_mov_b32 v24, v81
    s_nop 1
    v_permlane32_swap_b32 v81, v24
    s_nop 1
    v_add_f32 v81, v81, v24
    v_mov_b32 v24, v82
    s_nop 1
    v_permlane32_swap_b32 v82, v24
    s_nop 1
    v_add_f32 v82, v82, v24
    v_mov_b32 v24, v83
    s_nop 1
    v_permlane32_swap_b32 v83, v24
    s_nop 1
    v_add_f32 v83, v83, v24
    v_mov_b32 v24, v84
    s_nop 1
    v_permlane32_swap_b32 v84, v24
    s_nop 1
    v_add_f32 v84, v84, v24
    v_mov_b32 v24, v85
    s_nop 1
    v_permlane32_swap_b32 v85, v24
    s_nop 1
    v_add_f32 v85, v85, v24
    v_mov_b32 v24, v86
    s_nop 1
    v_permlane32_swap_b32 v86, v24
    s_nop 1
    v_add_f32 v86, v86, v24
    v_mov_b32 v24, v87
    s_nop 1
    v_permlane32_swap_b32 v87, v24
    s_nop 1
    v_add_f32 v87, v87, v24
    v_mov_b32 v24, v88
    s_nop 1
    v_permlane32_swap_b32 v88, v24
    s_nop 1
    v_add_f32 v88, v88, v24
    v_mov_b32 v24, v89
    s_nop 1
    v_permlane32_swap_b32 v89, v24
    s_nop 1
    v_add_f32 v89, v89, v24
    v_mov_b32 v24, v90
    s_nop 1
    v_permlane32_swap_b32 v90, v24
    s_nop 1
    v_add_f32 v90, v90, v24
    v_mov_b32 v24, v91
    s_nop 1
    v_permlane32_swap_b32 v91, v24
    s_nop 1
    v_add_f32 v91, v91, v24
    v_mov_b32 v24, v92
    s_nop 1
    v_permlane32_swap_b32 v92, v24
    s_nop 1
    v_add_f32 v92, v92, v24
    v_mov_b32 v24, v93
    s_nop 1
    v_permlane32_swap_b32 v93, v24
    s_nop 1
    v_add_f32 v93, v93, v24
    v_mov_b32 v24, v94
    s_nop 1
    v_permlane32_swap_b32 v94, v24
    s_nop 1
    v_add_f32 v94, v94, v24
    v_mov_b32 v24, v95
    s_nop 1
    v_permlane32_swap_b32 v95, v24
    s_nop 1
    v_add_f32 v95, v95, v24
    v_lshlrev_b32 v23, 8, v2
    v_lshl_add_u32 v23, v3, 6, v23
    v_add_u32 v23, 4096, v23
    v_cmp_gt_u32 vcc, 4, v1
    s_and_saveexec_b64 s[10:11], vcc
    ds_write_b128 v23, v[80:83] offset:0
    ds_write_b128 v23, v[84:87] offset:16
    ds_write_b128 v23, v[88:91] offset:32
    ds_write_b128 v23, v[92:95] offset:48
    s_mov_b64 exec, s[10:11]
    s_waitcnt lgkmcnt(0)
    s_barrier
    v_cmp_gt_u32 vcc, 64, v0
    s_and_saveexec_b64 s[10:11], vcc
    s_cbranch_execz k1_qproj_kernel_end
    v_lshrrev_b32 v24, 5, v0
    v_and_b32 v25, 31, v0
    v_lshrrev_b32 v26, 3, v25
    v_and_b32 v27, 7, v25
    v_lshlrev_b32 v28, 6, v26
    v_lshl_add_u32 v28, v24, 5, v28
    v_lshl_add_u32 v28, v27, 2, v28
    v_add_u32 v28, 4096, v28
    ds_read_b32 v30, v28 offset:0
    ds_read_b32 v31, v28 offset:256
    ds_read_b32 v32, v28 offset:512
    ds_read_b32 v33, v28 offset:768
    s_waitcnt lgkmcnt(0)
    v_add_f32 v30, v30, v31
    v_add_f32 v32, v32, v33
    v_add_f32 v30, v30, v32
    v_cvt_pk_bf16_f32 v30, v30, v30
    v_lshlrev_b32 v28, 13, v24
    v_lshl_add_u32 v28, v25, 1, v28
    v_add_u32 v28, s3, v28
    global_store_short v28, v30, s[8:9] offset:0
k1_qproj_kernel_end:
    s_endpgm
.globl k2_attn_kernel
.p2align 8
.type k2_attn_kernel,@function
k2_attn_kernel:
    s_cmp_ge_u32 s2, 256
    s_cbranch_scc1 k2_attn_kernel_end
    s_load_dwordx2 s[4:5], s[0:1], 8
    s_load_dwordx2 s[6:7], s[0:1], 16
    s_load_dwordx2 s[8:9], s[0:1], 88
    s_lshr_b32 s14, s2, 4
    s_and_b32 s15, s2, 15
    s_lshl_b32 s16, s14, 23
    s_lshl_b32 s17, s15, 16
    s_add_u32 s16, s16, s17
    s_add_u32 s16, s16, 7340032
    v_and_b32 v1, 63, v0
    v_lshrrev_b32 v2, 6, v0
    v_and_b32 v11, 15, v1
    v_lshrrev_b32 v12, 4, v1
    v_lshlrev_b32 v3, 14, v2
    v_lshl_add_u32 v3, v11, 8, v3
    v_lshl_add_u32 v3, v12, 4, v3
    v_add_u32 v4, 4096, v3
    v_add_u32 v5, 8192, v3
    v_add_u32 v6, 12288, v3
    v_lshlrev_b32 v7, 14, v2
    v_lshl_add_u32 v7, v12, 8, v7
    v_lshl_add_u32 v7, v11, 4, v7
    v_add_u32 v8, 4096, v7
    v_add_u32 v9, 8192, v7
    v_add_u32 v10, 12288, v7
    s_waitcnt lgkmcnt(0)
    s_add_u32 s10, s4, s16
    s_addc_u32 s11, s5, 0
    s_add_u32 s12, s6, s16
    s_addc_u32 s13, s7, 0
    global_load_dwordx4 v[16:19], v3, s[10:11] offset:0
    global_load_dwordx4 v[20:23], v3, s[10:11] offset:64
    global_load_dwordx4 v[24:27], v3, s[10:11] offset:128
    global_load_dwordx4 v[28:31], v3, s[10:11] offset:192
    global_load_dwordx4 v[32:35], v4, s[10:11] offset:0
    global_load_dwordx4 v[36:39], v4, s[10:11] offset:64
    global_load_dwordx4 v[40:43], v4, s[10:11] offset:128
    global_load_dwordx4 v[44:47], v4, s[10:11] offset:192
    global_load_dwordx4 v[48:51], v5, s[10:11] offset:0
    global_load_dwordx4 v[52:55], v5, s[10:11] offset:64
    global_load_dwordx4 v[56:59], v5, s[10:11] offset:128
    global_load_dwordx4 v[60:63], v5, s[10:11] offset:192
    global_load_dwordx4 v[64:67], v6, s[10:11] offset:0
    global_load_dwordx4 v[68:71], v6, s[10:11] offset:64
    global_load_dwordx4 v[72:75], v6, s[10:11] offset:128
    global_load_dwordx4 v[76:79], v6, s[10:11] offset:192
    v_mov_b32 v144, 0
    v_mov_b32 v145, 0
    v_mov_b32 v146, 0
    v_mov_b32 v147, 0
    v_mov_b32 v148, 0
    v_mov_b32 v149, 0
    v_mov_b32 v150, 0
    v_mov_b32 v151, 0
    v_mov_b32 v152, 0
    v_mov_b32 v153, 0
    v_mov_b32 v154, 0
    v_mov_b32 v155, 0
    v_mov_b32 v156, 0
    v_mov_b32 v157, 0
    v_mov_b32 v158, 0
    v_mov_b32 v159, 0
    s_lshl_b32 s18, s14, 10
    v_lshlrev_b32 v13, 8, v11
    v_lshl_add_u32 v13, v12, 4, v13
    v_add_u32 v13, s18, v13
    v_cmp_gt_u32 vcc, 4, v11
    s_and_saveexec_b64 s[20:21], vcc
    global_load_dwordx4 v[144:147], v13, s[8:9] offset:0
    global_load_dwordx4 v[148:151], v13, s[8:9] offset:64
    global_load_dwordx4 v[152:155], v13, s[8:9] offset:128
    global_load_dwordx4 v[156:159], v13, s[8:9] offset:192
    s_mov_b64 exec, s[20:21]
    global_load_dwordx4 v[80:83], v7, s[12:13] offset:0
    global_load_dwordx4 v[84:87], v7, s[12:13] offset:1024
    global_load_dwordx4 v[88:91], v7, s[12:13] offset:2048
    global_load_dwordx4 v[92:95], v7, s[12:13] offset:3072
    global_load_dwordx4 v[96:99], v8, s[12:13] offset:0
    global_load_dwordx4 v[100:103], v8, s[12:13] offset:1024
    global_load_dwordx4 v[104:107], v8, s[12:13] offset:2048
    global_load_dwordx4 v[108:111], v8, s[12:13] offset:3072
    global_load_dwordx4 v[112:115], v9, s[12:13] offset:0
    global_load_dwordx4 v[116:119], v9, s[12:13] offset:1024
    global_load_dwordx4 v[120:123], v9, s[12:13] offset:2048
    global_load_dwordx4 v[124:127], v9, s[12:13] offset:3072
    global_load_dwordx4 v[128:131], v10, s[12:13] offset:0
    global_load_dwordx4 v[132:135], v10, s[12:13] offset:1024
    global_load_dwordx4 v[136:139], v10, s[12:13] offset:2048
    global_load_dwordx4 v[140:143], v10, s[12:13] offset:3072
    v_mov_b32 v160, 0
    v_mov_b32 v161, 0
    v_mov_b32 v162, 0
    v_mov_b32 v163, 0
    v_mov_b32 v164, 0
    v_mov_b32 v165, 0
    v_mov_b32 v166, 0
    v_mov_b32 v167, 0
    v_mov_b32 v168, 0
    v_mov_b32 v169, 0
    v_mov_b32 v170, 0
    v_mov_b32 v171, 0
    v_mov_b32 v172, 0
    v_mov_b32 v173, 0
    v_mov_b32 v174, 0
    v_mov_b32 v175, 0
    s_waitcnt vmcnt(16)
    s_nop 1
    v_mfma_f32_16x16x32_bf16 v[160:163], v[144:147], v[16:19], v[160:163]
    v_mfma_f32_16x16x32_bf16 v[160:163], v[148:151], v[20:23], v[160:163]
    v_mfma_f32_16x16x32_bf16 v[160:163], v[152:155], v[24:27], v[160:163]
    v_mfma_f32_16x16x32_bf16 v[160:163], v[156:159], v[28:31], v[160:163]
    v_mfma_f32_16x16x32_bf16 v[164:167], v[144:147], v[32:35], v[164:167]
    v_mfma_f32_16x16x32_bf16 v[164:167], v[148:151], v[36:39], v[164:167]
    v_mfma_f32_16x16x32_bf16 v[164:167], v[152:155], v[40:43], v[164:167]
    v_mfma_f32_16x16x32_bf16 v[164:167], v[156:159], v[44:47], v[164:167]
    v_mfma_f32_16x16x32_bf16 v[168:171], v[144:147], v[48:51], v[168:171]
    v_mfma_f32_16x16x32_bf16 v[168:171], v[148:151], v[52:55], v[168:171]
    v_mfma_f32_16x16x32_bf16 v[168:171], v[152:155], v[56:59], v[168:171]
    v_mfma_f32_16x16x32_bf16 v[168:171], v[156:159], v[60:63], v[168:171]
    v_mfma_f32_16x16x32_bf16 v[172:175], v[144:147], v[64:67], v[172:175]
    v_mfma_f32_16x16x32_bf16 v[172:175], v[148:151], v[68:71], v[172:175]
    v_mfma_f32_16x16x32_bf16 v[172:175], v[152:155], v[72:75], v[172:175]
    v_mfma_f32_16x16x32_bf16 v[172:175], v[156:159], v[76:79], v[172:175]
    s_nop 15
    v_cvt_pk_bf16_f32 v160, v160, v160
    v_lshlrev_b32 v160, 16, v160
    v_mul_f32 v160, 0x3db504f3, v160
    v_cvt_pk_bf16_f32 v160, v160, v160
    v_lshlrev_b32 v160, 16, v160
    v_mul_f32 v160, 0x3fb8aa3b, v160
    v_cvt_pk_bf16_f32 v161, v161, v161
    v_lshlrev_b32 v161, 16, v161
    v_mul_f32 v161, 0x3db504f3, v161
    v_cvt_pk_bf16_f32 v161, v161, v161
    v_lshlrev_b32 v161, 16, v161
    v_mul_f32 v161, 0x3fb8aa3b, v161
    v_cvt_pk_bf16_f32 v162, v162, v162
    v_lshlrev_b32 v162, 16, v162
    v_mul_f32 v162, 0x3db504f3, v162
    v_cvt_pk_bf16_f32 v162, v162, v162
    v_lshlrev_b32 v162, 16, v162
    v_mul_f32 v162, 0x3fb8aa3b, v162
    v_cvt_pk_bf16_f32 v163, v163, v163
    v_lshlrev_b32 v163, 16, v163
    v_mul_f32 v163, 0x3db504f3, v163
    v_cvt_pk_bf16_f32 v163, v163, v163
    v_lshlrev_b32 v163, 16, v163
    v_mul_f32 v163, 0x3fb8aa3b, v163
    v_cvt_pk_bf16_f32 v164, v164, v164
    v_lshlrev_b32 v164, 16, v164
    v_mul_f32 v164, 0x3db504f3, v164
    v_cvt_pk_bf16_f32 v164, v164, v164
    v_lshlrev_b32 v164, 16, v164
    v_mul_f32 v164, 0x3fb8aa3b, v164
    v_cvt_pk_bf16_f32 v165, v165, v165
    v_lshlrev_b32 v165, 16, v165
    v_mul_f32 v165, 0x3db504f3, v165
    v_cvt_pk_bf16_f32 v165, v165, v165
    v_lshlrev_b32 v165, 16, v165
    v_mul_f32 v165, 0x3fb8aa3b, v165
    v_cvt_pk_bf16_f32 v166, v166, v166
    v_lshlrev_b32 v166, 16, v166
    v_mul_f32 v166, 0x3db504f3, v166
    v_cvt_pk_bf16_f32 v166, v166, v166
    v_lshlrev_b32 v166, 16, v166
    v_mul_f32 v166, 0x3fb8aa3b, v166
    v_cvt_pk_bf16_f32 v167, v167, v167
    v_lshlrev_b32 v167, 16, v167
    v_mul_f32 v167, 0x3db504f3, v167
    v_cvt_pk_bf16_f32 v167, v167, v167
    v_lshlrev_b32 v167, 16, v167
    v_mul_f32 v167, 0x3fb8aa3b, v167
    v_cvt_pk_bf16_f32 v168, v168, v168
    v_lshlrev_b32 v168, 16, v168
    v_mul_f32 v168, 0x3db504f3, v168
    v_cvt_pk_bf16_f32 v168, v168, v168
    v_lshlrev_b32 v168, 16, v168
    v_mul_f32 v168, 0x3fb8aa3b, v168
    v_cvt_pk_bf16_f32 v169, v169, v169
    v_lshlrev_b32 v169, 16, v169
    v_mul_f32 v169, 0x3db504f3, v169
    v_cvt_pk_bf16_f32 v169, v169, v169
    v_lshlrev_b32 v169, 16, v169
    v_mul_f32 v169, 0x3fb8aa3b, v169
    v_cvt_pk_bf16_f32 v170, v170, v170
    v_lshlrev_b32 v170, 16, v170
    v_mul_f32 v170, 0x3db504f3, v170
    v_cvt_pk_bf16_f32 v170, v170, v170
    v_lshlrev_b32 v170, 16, v170
    v_mul_f32 v170, 0x3fb8aa3b, v170
    v_cvt_pk_bf16_f32 v171, v171, v171
    v_lshlrev_b32 v171, 16, v171
    v_mul_f32 v171, 0x3db504f3, v171
    v_cvt_pk_bf16_f32 v171, v171, v171
    v_lshlrev_b32 v171, 16, v171
    v_mul_f32 v171, 0x3fb8aa3b, v171
    v_cvt_pk_bf16_f32 v172, v172, v172
    v_lshlrev_b32 v172, 16, v172
    v_mul_f32 v172, 0x3db504f3, v172
    v_cvt_pk_bf16_f32 v172, v172, v172
    v_lshlrev_b32 v172, 16, v172
    v_mul_f32 v172, 0x3fb8aa3b, v172
    v_cvt_pk_bf16_f32 v173, v173, v173
    v_lshlrev_b32 v173, 16, v173
    v_mul_f32 v173, 0x3db504f3, v173
    v_cvt_pk_bf16_f32 v173, v173, v173
    v_lshlrev_b32 v173, 16, v173
    v_mul_f32 v173, 0x3fb8aa3b, v173
    v_cvt_pk_bf16_f32 v174, v174, v174
    v_lshlrev_b32 v174, 16, v174
    v_mul_f32 v174, 0x3db504f3, v174
    v_cvt_pk_bf16_f32 v174, v174, v174
    v_lshlrev_b32 v174, 16, v174
    v_mul_f32 v174, 0x3fb8aa3b, v174
    v_cvt_pk_bf16_f32 v175, v175, v175
    v_lshlrev_b32 v175, 16, v175
    v_mul_f32 v175, 0x3db504f3, v175
    v_cvt_pk_bf16_f32 v175, v175, v175
    v_lshlrev_b32 v175, 16, v175
    v_mul_f32 v175, 0x3fb8aa3b, v175
    v_max_f32 v208, v160, v164
    v_max_f32 v216, v168, v172
    v_max_f32 v208, v208, v216
    v_max_f32 v209, v161, v165
    v_max_f32 v216, v169, v173
    v_max_f32 v209, v209, v216
    v_max_f32 v210, v162, v166
    v_max_f32 v216, v170, v174
    v_max_f32 v210, v210, v216
    v_max_f32 v211, v163, v167
    v_max_f32 v216, v171, v175
    v_max_f32 v211, v211, v216
    s_nop 1
    v_max_f32_dpp v208, v208, v208 row_ror:1 row_mask:0xf bank_mask:0xf
    v_max_f32_dpp v209, v209, v209 row_ror:1 row_mask:0xf bank_mask:0xf
    v_max_f32_dpp v210, v210, v210 row_ror:1 row_mask:0xf bank_mask:0xf
    v_max_f32_dpp v211, v211, v211 row_ror:1 row_mask:0xf bank_mask:0xf
    s_nop 1
    v_max_f32_dpp v208, v208, v208 row_ror:2 row_mask:0xf bank_mask:0xf
    v_max_f32_dpp v209, v209, v209 row_ror:2 row_mask:0xf bank_mask:0xf
    v_max_f32_dpp v210, v210, v210 row_ror:2 row_mask:0xf bank_mask:0xf
    v_max_f32_dpp v211, v211, v211 row_ror:2 row_mask:0xf bank_mask:0xf
    s_nop 1
    v_max_f32_dpp v208, v208, v208 row_ror:4 row_mask:0xf bank_mask:0xf
    v_max_f32_dpp v209, v209, v209 row_ror:4 row_mask:0xf bank_mask:0xf
    v_max_f32_dpp v210, v210, v210 row_ror:4 row_mask:0xf bank_mask:0xf
    v_max_f32_dpp v211, v211, v211 row_ror:4 row_mask:0xf bank_mask:0xf
    s_nop 1
    v_max_f32_dpp v208, v208, v208 row_ror:8 row_mask:0xf bank_mask:0xf
    v_max_f32_dpp v209, v209, v209 row_ror:8 row_mask:0xf bank_mask:0xf
    v_max_f32_dpp v210, v210, v210 row_ror:8 row_mask:0xf bank_mask:0xf
    v_max_f32_dpp v211, v211, v211 row_ror:8 row_mask:0xf bank_mask:0xf
    v_sub_f32 v160, v160, v208
    v_exp_f32 v160, v160
    v_sub_f32 v161, v161, v209
    v_exp_f32 v161, v161
    v_sub_f32 v162, v162, v210
    v_exp_f32 v162, v162
    v_sub_f32 v163, v163, v211
    v_exp_f32 v163, v163
    v_sub_f32 v164, v164, v208
    v_exp_f32 v164, v164
    v_sub_f32 v165, v165, v209
    v_exp_f32 v165, v165
    v_sub_f32 v166, v166, v210
    v_exp_f32 v166, v166
    v_sub_f32 v167, v167, v211
    v_exp_f32 v167, v167
    v_sub_f32 v168, v168, v208
    v_exp_f32 v168, v168
    v_sub_f32 v169, v169, v209
    v_exp_f32 v169, v169
    v_sub_f32 v170, v170, v210
    v_exp_f32 v170, v170
    v_sub_f32 v171, v171, v211
    v_exp_f32 v171, v171
    v_sub_f32 v172, v172, v208
    v_exp_f32 v172, v172
    v_sub_f32 v173, v173, v209
    v_exp_f32 v173, v173
    v_sub_f32 v174, v174, v210
    v_exp_f32 v174, v174
    v_sub_f32 v175, v175, v211
    v_exp_f32 v175, v175
    s_nop 0
    v_add_f32 v212, v160, v164
    v_add_f32 v216, v168, v172
    v_add_f32 v212, v212, v216
    v_add_f32 v213, v161, v165
    v_add_f32 v216, v169, v173
    v_add_f32 v213, v213, v216
    v_add_f32 v214, v162, v166
    v_add_f32 v216, v170, v174
    v_add_f32 v214, v214, v216
    v_add_f32 v215, v163, v167
    v_add_f32 v216, v171, v175
    v_add_f32 v215, v215, v216
    s_nop 1
    v_add_f32_dpp v212, v212, v212 row_ror:1 row_mask:0xf bank_mask:0xf
    v_add_f32_dpp v213, v213, v213 row_ror:1 row_mask:0xf bank_mask:0xf
    v_add_f32_dpp v214, v214, v214 row_ror:1 row_mask:0xf bank_mask:0xf
    v_add_f32_dpp v215, v215, v215 row_ror:1 row_mask:0xf bank_mask:0xf
    s_nop 1
    v_add_f32_dpp v212, v212, v212 row_ror:2 row_mask:0xf bank_mask:0xf
    v_add_f32_dpp v213, v213, v213 row_ror:2 row_mask:0xf bank_mask:0xf
    v_add_f32_dpp v214, v214, v214 row_ror:2 row_mask:0xf bank_mask:0xf
    v_add_f32_dpp v215, v215, v215 row_ror:2 row_mask:0xf bank_mask:0xf
    s_nop 1
    v_add_f32_dpp v212, v212, v212 row_ror:4 row_mask:0xf bank_mask:0xf
    v_add_f32_dpp v213, v213, v213 row_ror:4 row_mask:0xf bank_mask:0xf
    v_add_f32_dpp v214, v214, v214 row_ror:4 row_mask:0xf bank_mask:0xf
    v_add_f32_dpp v215, v215, v215 row_ror:4 row_mask:0xf bank_mask:0xf
    s_nop 1
    v_add_f32_dpp v212, v212, v212 row_ror:8 row_mask:0xf bank_mask:0xf
    v_add_f32_dpp v213, v213, v213 row_ror:8 row_mask:0xf bank_mask:0xf
    v_add_f32_dpp v214, v214, v214 row_ror:8 row_mask:0xf bank_mask:0xf
    v_add_f32_dpp v215, v215, v215 row_ror:8 row_mask:0xf bank_mask:0xf
    v_lshlrev_b32 v13, 10, v2
    v_lshl_add_u32 v14, v1, 4, v13
    v_add_u32 v14, 32768, v14
    v_cmp_gt_u32 vcc, 16, v1
    s_and_saveexec_b64 s[20:21], vcc
    ds_write_b128 v14, v[160:163] offset:0
    ds_write_b128 v14, v[164:167] offset:256
    ds_write_b128 v14, v[168:171] offset:512
    ds_write_b128 v14, v[172:175] offset:768
    v_cmp_eq_u32 vcc, 0, v1
    s_and_b64 exec, exec, vcc
    v_lshlrev_b32 v15, 5, v2
    v_add_u32 v15, 36864, v15
    ds_write_b128 v15, v[208:211]
    ds_write_b128 v15, v[212:215] offset:16
    s_mov_b64 exec, s[20:21]
    v_lshl_add_u32 v14, v12, 4, v13
    v_add_u32 v14, 32768, v14
    ds_read_b128 v[16:19], v14 offset:0
    ds_read_b128 v[20:23], v14 offset:64
    ds_read_b128 v[24:27], v14 offset:128
    ds_read_b128 v[28:31], v14 offset:192
    ds_read_b128 v[32:35], v14 offset:256
    ds_read_b128 v[36:39], v14 offset:320
    ds_read_b128 v[40:43], v14 offset:384
    ds_read_b128 v[44:47], v14 offset:448
    ds_read_b128 v[48:51], v14 offset:512
    ds_read_b128 v[52:55], v14 offset:576
    ds_read_b128 v[56:59], v14 offset:640
    ds_read_b128 v[60:63], v14 offset:704
    ds_read_b128 v[64:67], v14 offset:768
    ds_read_b128 v[68:71], v14 offset:832
    ds_read_b128 v[72:75], v14 offset:896
    ds_read_b128 v[76:79], v14 offset:960
    v_mov_b32 v176, 0
    v_mov_b32 v177, 0
    v_mov_b32 v178, 0
    v_mov_b32 v179, 0
    v_mov_b32 v180, 0
    v_mov_b32 v181, 0
    v_mov_b32 v182, 0
    v_mov_b32 v183, 0
    v_mov_b32 v184, 0
    v_mov_b32 v185, 0
    v_mov_b32 v186, 0
    v_mov_b32 v187, 0
    v_mov_b32 v188, 0
    v_mov_b32 v189, 0
    v_mov_b32 v190, 0
    v_mov_b32 v191, 0
    v_mov_b32 v192, 0
    v_mov_b32 v193, 0
    v_mov_b32 v194, 0
    v_mov_b32 v195, 0
    v_mov_b32 v196, 0
    v_mov_b32 v197, 0
    v_mov_b32 v198, 0
    v_mov_b32 v199, 0
    v_mov_b32 v200, 0
    v_mov_b32 v201, 0
    v_mov_b32 v202, 0
    v_mov_b32 v203, 0
    v_mov_b32 v204, 0
    v_mov_b32 v205, 0
    v_mov_b32 v206, 0
    v_mov_b32 v207, 0
    s_waitcnt lgkmcnt(0)
    s_waitcnt vmcnt(15)
    v_lshlrev_b32 v216, 16, v80
    v_and_b32 v217, 0xffff0000, v80
    v_lshlrev_b32 v218, 16, v81
    v_and_b32 v219, 0xffff0000, v81
    v_lshlrev_b32 v220, 16, v82
    v_and_b32 v221, 0xffff0000, v82
    v_lshlrev_b32 v222, 16, v83
    v_and_b32 v223, 0xffff0000, v83
    v_fmac_f32 v176, v16, v216
    v_fmac_f32 v177, v16, v217
    v_fmac_f32 v178, v16, v218
    v_fmac_f32 v179, v16, v219
    v_fmac_f32 v180, v16, v220
    v_fmac_f32 v181, v16, v221
    v_fmac_f32 v182, v16, v222
    v_fmac_f32 v183, v16, v223
    v_fmac_f32 v184, v17, v216
    v_fmac_f32 v185, v17, v217
    v_fmac_f32 v186, v17, v218
    v_fmac_f32 v187, v17, v219
    v_fmac_f32 v188, v17, v220
    v_fmac_f32 v189, v17, v221
    v_fmac_f32 v190, v17, v222
    v_fmac_f32 v191, v17, v223
    v_fmac_f32 v192, v18, v216
    v_fmac_f32 v193, v18, v217
    v_fmac_f32 v194, v18, v218
    v_fmac_f32 v195, v18, v219
    v_fmac_f32 v196, v18, v220
    v_fmac_f32 v197, v18, v221
    v_fmac_f32 v198, v18, v222
    v_fmac_f32 v199, v18, v223
    v_fmac_f32 v200, v19, v216
    v_fmac_f32 v201, v19, v217
    v_fmac_f32 v202, v19, v218
    v_fmac_f32 v203, v19, v219
    v_fmac_f32 v204, v19, v220
    v_fmac_f32 v205, v19, v221
    v_fmac_f32 v206, v19, v222
    v_fmac_f32 v207, v19, v223
    s_waitcnt vmcnt(14)
    v_lshlrev_b32 v216, 16, v84
    v_and_b32 v217, 0xffff0000, v84
    v_lshlrev_b32 v218, 16, v85
    v_and_b32 v219, 0xffff0000, v85
    v_lshlrev_b32 v220, 16, v86
    v_and_b32 v221, 0xffff0000, v86
    v_lshlrev_b32 v222, 16, v87
    v_and_b32 v223, 0xffff0000, v87
    v_fmac_f32 v176, v20, v216
    v_fmac_f32 v177, v20, v217
    v_fmac_f32 v178, v20, v218
    v_fmac_f32 v179, v20, v219
    v_fmac_f32 v180, v20, v220
    v_fmac_f32 v181, v20, v221
    v_fmac_f32 v182, v20, v222
    v_fmac_f32 v183, v20, v223
    v_fmac_f32 v184, v21, v216
    v_fmac_f32 v185, v21, v217
    v_fmac_f32 v186, v21, v218
    v_fmac_f32 v187, v21, v219
    v_fmac_f32 v188, v21, v220
    v_fmac_f32 v189, v21, v221
    v_fmac_f32 v190, v21, v222
    v_fmac_f32 v191, v21, v223
    v_fmac_f32 v192, v22, v216
    v_fmac_f32 v193, v22, v217
    v_fmac_f32 v194, v22, v218
    v_fmac_f32 v195, v22, v219
    v_fmac_f32 v196, v22, v220
    v_fmac_f32 v197, v22, v221
    v_fmac_f32 v198, v22, v222
    v_fmac_f32 v199, v22, v223
    v_fmac_f32 v200, v23, v216
    v_fmac_f32 v201, v23, v217
    v_fmac_f32 v202, v23, v218
    v_fmac_f32 v203, v23, v219
    v_fmac_f32 v204, v23, v220
    v_fmac_f32 v205, v23, v221
    v_fmac_f32 v206, v23, v222
    v_fmac_f32 v207, v23, v223
    s_waitcnt vmcnt(13)
    v_lshlrev_b32 v216, 16, v88
    v_and_b32 v217, 0xffff0000, v88
    v_lshlrev_b32 v218, 16, v89
    v_and_b32 v219, 0xffff0000, v89
    v_lshlrev_b32 v220, 16, v90
    v_and_b32 v221, 0xffff0000, v90
    v_lshlrev_b32 v222, 16, v91
    v_and_b32 v223, 0xffff0000, v91
    v_fmac_f32 v176, v24, v216
    v_fmac_f32 v177, v24, v217
    v_fmac_f32 v178, v24, v218
    v_fmac_f32 v179, v24, v219
    v_fmac_f32 v180, v24, v220
    v_fmac_f32 v181, v24, v221
    v_fmac_f32 v182, v24, v222
    v_fmac_f32 v183, v24, v223
    v_fmac_f32 v184, v25, v216
    v_fmac_f32 v185, v25, v217
    v_fmac_f32 v186, v25, v218
    v_fmac_f32 v187, v25, v219
    v_fmac_f32 v188, v25, v220
    v_fmac_f32 v189, v25, v221
    v_fmac_f32 v190, v25, v222
    v_fmac_f32 v191, v25, v223
    v_fmac_f32 v192, v26, v216
    v_fmac_f32 v193, v26, v217
    v_fmac_f32 v194, v26, v218
    v_fmac_f32 v195, v26, v219
    v_fmac_f32 v196, v26, v220
    v_fmac_f32 v197, v26, v221
    v_fmac_f32 v198, v26, v222
    v_fmac_f32 v199, v26, v223
    v_fmac_f32 v200, v27, v216
    v_fmac_f32 v201, v27, v217
    v_fmac_f32 v202, v27, v218
    v_fmac_f32 v203, v27, v219
    v_fmac_f32 v204, v27, v220
    v_fmac_f32 v205, v27, v221
    v_fmac_f32 v206, v27, v222
    v_fmac_f32 v207, v27, v223
    s_waitcnt vmcnt(12)
    v_lshlrev_b32 v216, 16, v92
    v_and_b32 v217, 0xffff0000, v92
    v_lshlrev_b32 v218, 16, v93
    v_and_b32 v219, 0xffff0000, v93
    v_lshlrev_b32 v220, 16, v94
    v_and_b32 v221, 0xffff0000, v94
    v_lshlrev_b32 v222, 16, v95
    v_and_b32 v223, 0xffff0000, v95
    v_fmac_f32 v176, v28, v216
    v_fmac_f32 v177, v28, v217
    v_fmac_f32 v178, v28, v218
    v_fmac_f32 v179, v28, v219
    v_fmac_f32 v180, v28, v220
    v_fmac_f32 v181, v28, v221
    v_fmac_f32 v182, v28, v222
    v_fmac_f32 v183, v28, v223
    v_fmac_f32 v184, v29, v216
    v_fmac_f32 v185, v29, v217
    v_fmac_f32 v186, v29, v218
    v_fmac_f32 v187, v29, v219
    v_fmac_f32 v188, v29, v220
    v_fmac_f32 v189, v29, v221
    v_fmac_f32 v190, v29, v222
    v_fmac_f32 v191, v29, v223
    v_fmac_f32 v192, v30, v216
    v_fmac_f32 v193, v30, v217
    v_fmac_f32 v194, v30, v218
    v_fmac_f32 v195, v30, v219
    v_fmac_f32 v196, v30, v220
    v_fmac_f32 v197, v30, v221
    v_fmac_f32 v198, v30, v222
    v_fmac_f32 v199, v30, v223
    v_fmac_f32 v200, v31, v216
    v_fmac_f32 v201, v31, v217
    v_fmac_f32 v202, v31, v218
    v_fmac_f32 v203, v31, v219
    v_fmac_f32 v204, v31, v220
    v_fmac_f32 v205, v31, v221
    v_fmac_f32 v206, v31, v222
    v_fmac_f32 v207, v31, v223
    s_waitcnt vmcnt(11)
    v_lshlrev_b32 v216, 16, v96
    v_and_b32 v217, 0xffff0000, v96
    v_lshlrev_b32 v218, 16, v97
    v_and_b32 v219, 0xffff0000, v97
    v_lshlrev_b32 v220, 16, v98
    v_and_b32 v221, 0xffff0000, v98
    v_lshlrev_b32 v222, 16, v99
    v_and_b32 v223, 0xffff0000, v99
    v_fmac_f32 v176, v32, v216
    v_fmac_f32 v177, v32, v217
    v_fmac_f32 v178, v32, v218
    v_fmac_f32 v179, v32, v219
    v_fmac_f32 v180, v32, v220
    v_fmac_f32 v181, v32, v221
    v_fmac_f32 v182, v32, v222
    v_fmac_f32 v183, v32, v223
    v_fmac_f32 v184, v33, v216
    v_fmac_f32 v185, v33, v217
    v_fmac_f32 v186, v33, v218
    v_fmac_f32 v187, v33, v219
    v_fmac_f32 v188, v33, v220
    v_fmac_f32 v189, v33, v221
    v_fmac_f32 v190, v33, v222
    v_fmac_f32 v191, v33, v223
    v_fmac_f32 v192, v34, v216
    v_fmac_f32 v193, v34, v217
    v_fmac_f32 v194, v34, v218
    v_fmac_f32 v195, v34, v219
    v_fmac_f32 v196, v34, v220
    v_fmac_f32 v197, v34, v221
    v_fmac_f32 v198, v34, v222
    v_fmac_f32 v199, v34, v223
    v_fmac_f32 v200, v35, v216
    v_fmac_f32 v201, v35, v217
    v_fmac_f32 v202, v35, v218
    v_fmac_f32 v203, v35, v219
    v_fmac_f32 v204, v35, v220
    v_fmac_f32 v205, v35, v221
    v_fmac_f32 v206, v35, v222
    v_fmac_f32 v207, v35, v223
    s_waitcnt vmcnt(10)
    v_lshlrev_b32 v216, 16, v100
    v_and_b32 v217, 0xffff0000, v100
    v_lshlrev_b32 v218, 16, v101
    v_and_b32 v219, 0xffff0000, v101
    v_lshlrev_b32 v220, 16, v102
    v_and_b32 v221, 0xffff0000, v102
    v_lshlrev_b32 v222, 16, v103
    v_and_b32 v223, 0xffff0000, v103
    v_fmac_f32 v176, v36, v216
    v_fmac_f32 v177, v36, v217
    v_fmac_f32 v178, v36, v218
    v_fmac_f32 v179, v36, v219
    v_fmac_f32 v180, v36, v220
    v_fmac_f32 v181, v36, v221
    v_fmac_f32 v182, v36, v222
    v_fmac_f32 v183, v36, v223
    v_fmac_f32 v184, v37, v216
    v_fmac_f32 v185, v37, v217
    v_fmac_f32 v186, v37, v218
    v_fmac_f32 v187, v37, v219
    v_fmac_f32 v188, v37, v220
    v_fmac_f32 v189, v37, v221
    v_fmac_f32 v190, v37, v222
    v_fmac_f32 v191, v37, v223
    v_fmac_f32 v192, v38, v216
    v_fmac_f32 v193, v38, v217
    v_fmac_f32 v194, v38, v218
    v_fmac_f32 v195, v38, v219
    v_fmac_f32 v196, v38, v220
    v_fmac_f32 v197, v38, v221
    v_fmac_f32 v198, v38, v222
    v_fmac_f32 v199, v38, v223
    v_fmac_f32 v200, v39, v216
    v_fmac_f32 v201, v39, v217
    v_fmac_f32 v202, v39, v218
    v_fmac_f32 v203, v39, v219
    v_fmac_f32 v204, v39, v220
    v_fmac_f32 v205, v39, v221
    v_fmac_f32 v206, v39, v222
    v_fmac_f32 v207, v39, v223
    s_waitcnt vmcnt(9)
    v_lshlrev_b32 v216, 16, v104
    v_and_b32 v217, 0xffff0000, v104
    v_lshlrev_b32 v218, 16, v105
    v_and_b32 v219, 0xffff0000, v105
    v_lshlrev_b32 v220, 16, v106
    v_and_b32 v221, 0xffff0000, v106
    v_lshlrev_b32 v222, 16, v107
    v_and_b32 v223, 0xffff0000, v107
    v_fmac_f32 v176, v40, v216
    v_fmac_f32 v177, v40, v217
    v_fmac_f32 v178, v40, v218
    v_fmac_f32 v179, v40, v219
    v_fmac_f32 v180, v40, v220
    v_fmac_f32 v181, v40, v221
    v_fmac_f32 v182, v40, v222
    v_fmac_f32 v183, v40, v223
    v_fmac_f32 v184, v41, v216
    v_fmac_f32 v185, v41, v217
    v_fmac_f32 v186, v41, v218
    v_fmac_f32 v187, v41, v219
    v_fmac_f32 v188, v41, v220
    v_fmac_f32 v189, v41, v221
    v_fmac_f32 v190, v41, v222
    v_fmac_f32 v191, v41, v223
    v_fmac_f32 v192, v42, v216
    v_fmac_f32 v193, v42, v217
    v_fmac_f32 v194, v42, v218
    v_fmac_f32 v195, v42, v219
    v_fmac_f32 v196, v42, v220
    v_fmac_f32 v197, v42, v221
    v_fmac_f32 v198, v42, v222
    v_fmac_f32 v199, v42, v223
    v_fmac_f32 v200, v43, v216
    v_fmac_f32 v201, v43, v217
    v_fmac_f32 v202, v43, v218
    v_fmac_f32 v203, v43, v219
    v_fmac_f32 v204, v43, v220
    v_fmac_f32 v205, v43, v221
    v_fmac_f32 v206, v43, v222
    v_fmac_f32 v207, v43, v223
    s_waitcnt vmcnt(8)
    v_lshlrev_b32 v216, 16, v108
    v_and_b32 v217, 0xffff0000, v108
    v_lshlrev_b32 v218, 16, v109
    v_and_b32 v219, 0xffff0000, v109
    v_lshlrev_b32 v220, 16, v110
    v_and_b32 v221, 0xffff0000, v110
    v_lshlrev_b32 v222, 16, v111
    v_and_b32 v223, 0xffff0000, v111
    v_fmac_f32 v176, v44, v216
    v_fmac_f32 v177, v44, v217
    v_fmac_f32 v178, v44, v218
    v_fmac_f32 v179, v44, v219
    v_fmac_f32 v180, v44, v220
    v_fmac_f32 v181, v44, v221
    v_fmac_f32 v182, v44, v222
    v_fmac_f32 v183, v44, v223
    v_fmac_f32 v184, v45, v216
    v_fmac_f32 v185, v45, v217
    v_fmac_f32 v186, v45, v218
    v_fmac_f32 v187, v45, v219
    v_fmac_f32 v188, v45, v220
    v_fmac_f32 v189, v45, v221
    v_fmac_f32 v190, v45, v222
    v_fmac_f32 v191, v45, v223
    v_fmac_f32 v192, v46, v216
    v_fmac_f32 v193, v46, v217
    v_fmac_f32 v194, v46, v218
    v_fmac_f32 v195, v46, v219
    v_fmac_f32 v196, v46, v220
    v_fmac_f32 v197, v46, v221
    v_fmac_f32 v198, v46, v222
    v_fmac_f32 v199, v46, v223
    v_fmac_f32 v200, v47, v216
    v_fmac_f32 v201, v47, v217
    v_fmac_f32 v202, v47, v218
    v_fmac_f32 v203, v47, v219
    v_fmac_f32 v204, v47, v220
    v_fmac_f32 v205, v47, v221
    v_fmac_f32 v206, v47, v222
    v_fmac_f32 v207, v47, v223
    s_waitcnt vmcnt(7)
    v_lshlrev_b32 v216, 16, v112
    v_and_b32 v217, 0xffff0000, v112
    v_lshlrev_b32 v218, 16, v113
    v_and_b32 v219, 0xffff0000, v113
    v_lshlrev_b32 v220, 16, v114
    v_and_b32 v221, 0xffff0000, v114
    v_lshlrev_b32 v222, 16, v115
    v_and_b32 v223, 0xffff0000, v115
    v_fmac_f32 v176, v48, v216
    v_fmac_f32 v177, v48, v217
    v_fmac_f32 v178, v48, v218
    v_fmac_f32 v179, v48, v219
    v_fmac_f32 v180, v48, v220
    v_fmac_f32 v181, v48, v221
    v_fmac_f32 v182, v48, v222
    v_fmac_f32 v183, v48, v223
    v_fmac_f32 v184, v49, v216
    v_fmac_f32 v185, v49, v217
    v_fmac_f32 v186, v49, v218
    v_fmac_f32 v187, v49, v219
    v_fmac_f32 v188, v49, v220
    v_fmac_f32 v189, v49, v221
    v_fmac_f32 v190, v49, v222
    v_fmac_f32 v191, v49, v223
    v_fmac_f32 v192, v50, v216
    v_fmac_f32 v193, v50, v217
    v_fmac_f32 v194, v50, v218
    v_fmac_f32 v195, v50, v219
    v_fmac_f32 v196, v50, v220
    v_fmac_f32 v197, v50, v221
    v_fmac_f32 v198, v50, v222
    v_fmac_f32 v199, v50, v223
    v_fmac_f32 v200, v51, v216
    v_fmac_f32 v201, v51, v217
    v_fmac_f32 v202, v51, v218
    v_fmac_f32 v203, v51, v219
    v_fmac_f32 v204, v51, v220
    v_fmac_f32 v205, v51, v221
    v_fmac_f32 v206, v51, v222
    v_fmac_f32 v207, v51, v223
    s_waitcnt vmcnt(6)
    v_lshlrev_b32 v216, 16, v116
    v_and_b32 v217, 0xffff0000, v116
    v_lshlrev_b32 v218, 16, v117
    v_and_b32 v219, 0xffff0000, v117
    v_lshlrev_b32 v220, 16, v118
    v_and_b32 v221, 0xffff0000, v118
    v_lshlrev_b32 v222, 16, v119
    v_and_b32 v223, 0xffff0000, v119
    v_fmac_f32 v176, v52, v216
    v_fmac_f32 v177, v52, v217
    v_fmac_f32 v178, v52, v218
    v_fmac_f32 v179, v52, v219
    v_fmac_f32 v180, v52, v220
    v_fmac_f32 v181, v52, v221
    v_fmac_f32 v182, v52, v222
    v_fmac_f32 v183, v52, v223
    v_fmac_f32 v184, v53, v216
    v_fmac_f32 v185, v53, v217
    v_fmac_f32 v186, v53, v218
    v_fmac_f32 v187, v53, v219
    v_fmac_f32 v188, v53, v220
    v_fmac_f32 v189, v53, v221
    v_fmac_f32 v190, v53, v222
    v_fmac_f32 v191, v53, v223
    v_fmac_f32 v192, v54, v216
    v_fmac_f32 v193, v54, v217
    v_fmac_f32 v194, v54, v218
    v_fmac_f32 v195, v54, v219
    v_fmac_f32 v196, v54, v220
    v_fmac_f32 v197, v54, v221
    v_fmac_f32 v198, v54, v222
    v_fmac_f32 v199, v54, v223
    v_fmac_f32 v200, v55, v216
    v_fmac_f32 v201, v55, v217
    v_fmac_f32 v202, v55, v218
    v_fmac_f32 v203, v55, v219
    v_fmac_f32 v204, v55, v220
    v_fmac_f32 v205, v55, v221
    v_fmac_f32 v206, v55, v222
    v_fmac_f32 v207, v55, v223
    s_waitcnt vmcnt(5)
    v_lshlrev_b32 v216, 16, v120
    v_and_b32 v217, 0xffff0000, v120
    v_lshlrev_b32 v218, 16, v121
    v_and_b32 v219, 0xffff0000, v121
    v_lshlrev_b32 v220, 16, v122
    v_and_b32 v221, 0xffff0000, v122
    v_lshlrev_b32 v222, 16, v123
    v_and_b32 v223, 0xffff0000, v123
    v_fmac_f32 v176, v56, v216
    v_fmac_f32 v177, v56, v217
    v_fmac_f32 v178, v56, v218
    v_fmac_f32 v179, v56, v219
    v_fmac_f32 v180, v56, v220
    v_fmac_f32 v181, v56, v221
    v_fmac_f32 v182, v56, v222
    v_fmac_f32 v183, v56, v223
    v_fmac_f32 v184, v57, v216
    v_fmac_f32 v185, v57, v217
    v_fmac_f32 v186, v57, v218
    v_fmac_f32 v187, v57, v219
    v_fmac_f32 v188, v57, v220
    v_fmac_f32 v189, v57, v221
    v_fmac_f32 v190, v57, v222
    v_fmac_f32 v191, v57, v223
    v_fmac_f32 v192, v58, v216
    v_fmac_f32 v193, v58, v217
    v_fmac_f32 v194, v58, v218
    v_fmac_f32 v195, v58, v219
    v_fmac_f32 v196, v58, v220
    v_fmac_f32 v197, v58, v221
    v_fmac_f32 v198, v58, v222
    v_fmac_f32 v199, v58, v223
    v_fmac_f32 v200, v59, v216
    v_fmac_f32 v201, v59, v217
    v_fmac_f32 v202, v59, v218
    v_fmac_f32 v203, v59, v219
    v_fmac_f32 v204, v59, v220
    v_fmac_f32 v205, v59, v221
    v_fmac_f32 v206, v59, v222
    v_fmac_f32 v207, v59, v223
    s_waitcnt vmcnt(4)
    v_lshlrev_b32 v216, 16, v124
    v_and_b32 v217, 0xffff0000, v124
    v_lshlrev_b32 v218, 16, v125
    v_and_b32 v219, 0xffff0000, v125
    v_lshlrev_b32 v220, 16, v126
    v_and_b32 v221, 0xffff0000, v126
    v_lshlrev_b32 v222, 16, v127
    v_and_b32 v223, 0xffff0000, v127
    v_fmac_f32 v176, v60, v216
    v_fmac_f32 v177, v60, v217
    v_fmac_f32 v178, v60, v218
    v_fmac_f32 v179, v60, v219
    v_fmac_f32 v180, v60, v220
    v_fmac_f32 v181, v60, v221
    v_fmac_f32 v182, v60, v222
    v_fmac_f32 v183, v60, v223
    v_fmac_f32 v184, v61, v216
    v_fmac_f32 v185, v61, v217
    v_fmac_f32 v186, v61, v218
    v_fmac_f32 v187, v61, v219
    v_fmac_f32 v188, v61, v220
    v_fmac_f32 v189, v61, v221
    v_fmac_f32 v190, v61, v222
    v_fmac_f32 v191, v61, v223
    v_fmac_f32 v192, v62, v216
    v_fmac_f32 v193, v62, v217
    v_fmac_f32 v194, v62, v218
    v_fmac_f32 v195, v62, v219
    v_fmac_f32 v196, v62, v220
    v_fmac_f32 v197, v62, v221
    v_fmac_f32 v198, v62, v222
    v_fmac_f32 v199, v62, v223
    v_fmac_f32 v200, v63, v216
    v_fmac_f32 v201, v63, v217
    v_fmac_f32 v202, v63, v218
    v_fmac_f32 v203, v63, v219
    v_fmac_f32 v204, v63, v220
    v_fmac_f32 v205, v63, v221
    v_fmac_f32 v206, v63, v222
    v_fmac_f32 v207, v63, v223
    s_waitcnt vmcnt(3)
    v_lshlrev_b32 v216, 16, v128
    v_and_b32 v217, 0xffff0000, v128
    v_lshlrev_b32 v218, 16, v129
    v_and_b32 v219, 0xffff0000, v129
    v_lshlrev_b32 v220, 16, v130
    v_and_b32 v221, 0xffff0000, v130
    v_lshlrev_b32 v222, 16, v131
    v_and_b32 v223, 0xffff0000, v131
    v_fmac_f32 v176, v64, v216
    v_fmac_f32 v177, v64, v217
    v_fmac_f32 v178, v64, v218
    v_fmac_f32 v179, v64, v219
    v_fmac_f32 v180, v64, v220
    v_fmac_f32 v181, v64, v221
    v_fmac_f32 v182, v64, v222
    v_fmac_f32 v183, v64, v223
    v_fmac_f32 v184, v65, v216
    v_fmac_f32 v185, v65, v217
    v_fmac_f32 v186, v65, v218
    v_fmac_f32 v187, v65, v219
    v_fmac_f32 v188, v65, v220
    v_fmac_f32 v189, v65, v221
    v_fmac_f32 v190, v65, v222
    v_fmac_f32 v191, v65, v223
    v_fmac_f32 v192, v66, v216
    v_fmac_f32 v193, v66, v217
    v_fmac_f32 v194, v66, v218
    v_fmac_f32 v195, v66, v219
    v_fmac_f32 v196, v66, v220
    v_fmac_f32 v197, v66, v221
    v_fmac_f32 v198, v66, v222
    v_fmac_f32 v199, v66, v223
    v_fmac_f32 v200, v67, v216
    v_fmac_f32 v201, v67, v217
    v_fmac_f32 v202, v67, v218
    v_fmac_f32 v203, v67, v219
    v_fmac_f32 v204, v67, v220
    v_fmac_f32 v205, v67, v221
    v_fmac_f32 v206, v67, v222
    v_fmac_f32 v207, v67, v223
    s_waitcnt vmcnt(2)
    v_lshlrev_b32 v216, 16, v132
    v_and_b32 v217, 0xffff0000, v132
    v_lshlrev_b32 v218, 16, v133
    v_and_b32 v219, 0xffff0000, v133
    v_lshlrev_b32 v220, 16, v134
    v_and_b32 v221, 0xffff0000, v134
    v_lshlrev_b32 v222, 16, v135
    v_and_b32 v223, 0xffff0000, v135
    v_fmac_f32 v176, v68, v216
    v_fmac_f32 v177, v68, v217
    v_fmac_f32 v178, v68, v218
    v_fmac_f32 v179, v68, v219
    v_fmac_f32 v180, v68, v220
    v_fmac_f32 v181, v68, v221
    v_fmac_f32 v182, v68, v222
    v_fmac_f32 v183, v68, v223
    v_fmac_f32 v184, v69, v216
    v_fmac_f32 v185, v69, v217
    v_fmac_f32 v186, v69, v218
    v_fmac_f32 v187, v69, v219
    v_fmac_f32 v188, v69, v220
    v_fmac_f32 v189, v69, v221
    v_fmac_f32 v190, v69, v222
    v_fmac_f32 v191, v69, v223
    v_fmac_f32 v192, v70, v216
    v_fmac_f32 v193, v70, v217
    v_fmac_f32 v194, v70, v218
    v_fmac_f32 v195, v70, v219
    v_fmac_f32 v196, v70, v220
    v_fmac_f32 v197, v70, v221
    v_fmac_f32 v198, v70, v222
    v_fmac_f32 v199, v70, v223
    v_fmac_f32 v200, v71, v216
    v_fmac_f32 v201, v71, v217
    v_fmac_f32 v202, v71, v218
    v_fmac_f32 v203, v71, v219
    v_fmac_f32 v204, v71, v220
    v_fmac_f32 v205, v71, v221
    v_fmac_f32 v206, v71, v222
    v_fmac_f32 v207, v71, v223
    s_waitcnt vmcnt(1)
    v_lshlrev_b32 v216, 16, v136
    v_and_b32 v217, 0xffff0000, v136
    v_lshlrev_b32 v218, 16, v137
    v_and_b32 v219, 0xffff0000, v137
    v_lshlrev_b32 v220, 16, v138
    v_and_b32 v221, 0xffff0000, v138
    v_lshlrev_b32 v222, 16, v139
    v_and_b32 v223, 0xffff0000, v139
    v_fmac_f32 v176, v72, v216
    v_fmac_f32 v177, v72, v217
    v_fmac_f32 v178, v72, v218
    v_fmac_f32 v179, v72, v219
    v_fmac_f32 v180, v72, v220
    v_fmac_f32 v181, v72, v221
    v_fmac_f32 v182, v72, v222
    v_fmac_f32 v183, v72, v223
    v_fmac_f32 v184, v73, v216
    v_fmac_f32 v185, v73, v217
    v_fmac_f32 v186, v73, v218
    v_fmac_f32 v187, v73, v219
    v_fmac_f32 v188, v73, v220
    v_fmac_f32 v189, v73, v221
    v_fmac_f32 v190, v73, v222
    v_fmac_f32 v191, v73, v223
    v_fmac_f32 v192, v74, v216
    v_fmac_f32 v193, v74, v217
    v_fmac_f32 v194, v74, v218
    v_fmac_f32 v195, v74, v219
    v_fmac_f32 v196, v74, v220
    v_fmac_f32 v197, v74, v221
    v_fmac_f32 v198, v74, v222
    v_fmac_f32 v199, v74, v223
    v_fmac_f32 v200, v75, v216
    v_fmac_f32 v201, v75, v217
    v_fmac_f32 v202, v75, v218
    v_fmac_f32 v203, v75, v219
    v_fmac_f32 v204, v75, v220
    v_fmac_f32 v205, v75, v221
    v_fmac_f32 v206, v75, v222
    v_fmac_f32 v207, v75, v223
    s_waitcnt vmcnt(0)
    v_lshlrev_b32 v216, 16, v140
    v_and_b32 v217, 0xffff0000, v140
    v_lshlrev_b32 v218, 16, v141
    v_and_b32 v219, 0xffff0000, v141
    v_lshlrev_b32 v220, 16, v142
    v_and_b32 v221, 0xffff0000, v142
    v_lshlrev_b32 v222, 16, v143
    v_and_b32 v223, 0xffff0000, v143
    v_fmac_f32 v176, v76, v216
    v_fmac_f32 v177, v76, v217
    v_fmac_f32 v178, v76, v218
    v_fmac_f32 v179, v76, v219
    v_fmac_f32 v180, v76, v220
    v_fmac_f32 v181, v76, v221
    v_fmac_f32 v182, v76, v222
    v_fmac_f32 v183, v76, v223
    v_fmac_f32 v184, v77, v216
    v_fmac_f32 v185, v77, v217
    v_fmac_f32 v186, v77, v218
    v_fmac_f32 v187, v77, v219
    v_fmac_f32 v188, v77, v220
    v_fmac_f32 v189, v77, v221
    v_fmac_f32 v190, v77, v222
    v_fmac_f32 v191, v77, v223
    v_fmac_f32 v192, v78, v216
    v_fmac_f32 v193, v78, v217
    v_fmac_f32 v194, v78, v218
    v_fmac_f32 v195, v78, v219
    v_fmac_f32 v196, v78, v220
    v_fmac_f32 v197, v78, v221
    v_fmac_f32 v198, v78, v222
    v_fmac_f32 v199, v78, v223
    v_fmac_f32 v200, v79, v216
    v_fmac_f32 v201, v79, v217
    v_fmac_f32 v202, v79, v218
    v_fmac_f32 v203, v79, v219
    v_fmac_f32 v204, v79, v220
    v_fmac_f32 v205, v79, v221
    v_fmac_f32 v206, v79, v222
    v_fmac_f32 v207, v79, v223
    v_lshlrev_b32 v14, 2, v2
    v_add_u32 v14, v14, v12
    v_lshlrev_b32 v14, 11, v14
    v_lshl_add_u32 v14, v11, 5, v14
    ds_write_b128 v14, v[176:179] offset:0
    ds_write_b128 v14, v[180:183] offset:16
    ds_write_b128 v14, v[184:187] offset:512
    ds_write_b128 v14, v[188:191] offset:528
    ds_write_b128 v14, v[192:195] offset:1024
    ds_write_b128 v14, v[196:199] offset:1040
    ds_write_b128 v14, v[200:203] offset:1536
    ds_write_b128 v14, v[204:207] offset:1552
    s_waitcnt lgkmcnt(0)
    s_barrier
    v_lshlrev_b32 v14, 9, v2
    v_lshl_add_u32 v14, v1, 3, v14
    ds_read_b64 v[16:17], v14 offset:0
    ds_read_b64 v[18:19], v14 offset:2048
    ds_read_b64 v[20:21], v14 offset:4096
    ds_read_b64 v[22:23], v14 offset:6144
    ds_read_b64 v[24:25], v14 offset:8192
    ds_read_b64 v[26:27], v14 offset:10240
    ds_read_b64 v[28:29], v14 offset:12288
    ds_read_b64 v[30:31], v14 offset:14336
    ds_read_b64 v[32:33], v14 offset:16384
    ds_read_b64 v[34:35], v14 offset:18432
    ds_read_b64 v[36:37], v14 offset:20480
    ds_read_b64 v[38:39], v14 offset:22528
    ds_read_b64 v[40:41], v14 offset:24576
    ds_read_b64 v[42:43], v14 offset:26624
    ds_read_b64 v[44:45], v14 offset:28672
    ds_read_b64 v[46:47], v14 offset:30720
    v_lshlrev_b32 v15, 2, v2
    ds_read_b32 v48, v15 offset:36864
    ds_read_b32 v52, v15 offset:36880
    ds_read_b32 v49, v15 offset:36896
    ds_read_b32 v53, v15 offset:36912
    ds_read_b32 v50, v15 offset:36928
    ds_read_b32 v54, v15 offset:36944
    ds_read_b32 v51, v15 offset:36960
    ds_read_b32 v55, v15 offset:36976
    s_waitcnt lgkmcnt(0)
    v_max_f32 v56, v48, v49
    v_max_f32 v57, v50, v51
    v_max_f32 v56, v56, v57
    v_sub_f32 v48, v48, v56
    v_exp_f32 v48, v48
    v_sub_f32 v49, v49, v56
    v_exp_f32 v49, v49
    v_sub_f32 v50, v50, v56
    v_exp_f32 v50, v50
    v_sub_f32 v51, v51, v56
    v_exp_f32 v51, v51
    s_nop 0
    v_mul_f32 v57, v48, v52
    v_fmac_f32 v57, v49, v53
    v_fmac_f32 v57, v50, v54
    v_fmac_f32 v57, v51, v55
    v_mov_b32 v58, 0
    v_mov_b32 v59, 0
    v_fmac_f32 v58, v48, v16
    v_fmac_f32 v59, v48, v17
    v_fmac_f32 v58, v48, v18
    v_fmac_f32 v59, v48, v19
    v_fmac_f32 v58, v48, v20
    v_fmac_f32 v59, v48, v21
    v_fmac_f32 v58, v48, v22
    v_fmac_f32 v59, v48, v23
    v_fmac_f32 v58, v49, v24
    v_fmac_f32 v59, v49, v25
    v_fmac_f32 v58, v49, v26
    v_fmac_f32 v59, v49, v27
    v_fmac_f32 v58, v49, v28
    v_fmac_f32 v59, v49, v29
    v_fmac_f32 v58, v49, v30
    v_fmac_f32 v59, v49, v31
    v_fmac_f32 v58, v50, v32
    v_fmac_f32 v59, v50, v33
    v_fmac_f32 v58, v50, v34
    v_fmac_f32 v59, v50, v35
    v_fmac_f32 v58, v50, v36
    v_fmac_f32 v59, v50, v37
    v_fmac_f32 v58, v50, v38
    v_fmac_f32 v59, v50, v39
    v_fmac_f32 v58, v51, v40
    v_fmac_f32 v59, v51, v41
    v_fmac_f32 v58, v51, v42
    v_fmac_f32 v59, v51, v43
    v_fmac_f32 v58, v51, v44
    v_fmac_f32 v59, v51, v45
    v_fmac_f32 v58, v51, v46
    v_fmac_f32 v59, v51, v47
    s_lshl_b32 s18, s14, 6
    s_add_u32 s18, s18, s15
    v_lshlrev_b32 v14, 4, v2
    v_add_u32 v14, s18, v14
    v_lshlrev_b32 v15, 9, v14
    v_lshl_add_u32 v15, v1, 3, v15
    v_add_u32 v15, 65536, v15
    global_store_dwordx2 v15, v[58:59], s[8:9]
    v_lshlrev_b32 v15, 3, v14
    v_add_u32 v15, 32768, v15
    v_cmp_eq_u32 vcc, 0, v1
    s_and_saveexec_b64 s[20:21], vcc
    global_store_dwordx2 v15, v[56:57], s[8:9] offset:0
k2_attn_kernel_end:
    s_endpgm
.globl k3_oproj_kernel
.p2align 8
.type k3_oproj_kernel,@function
k3_oproj_kernel:
    s_cmp_ge_u32 s2, 256
    s_cbranch_scc1 k3_oproj_kernel_end
    s_load_dwordx2 s[6:7], s[0:1], 32
    s_load_dwordx2 s[8:9], s[0:1], 88
    s_lshr_b32 s14, s2, 4
    s_and_b32 s15, s2, 15
    v_and_b32 v1, 63, v0
    v_lshrrev_b32 v2, 6, v0
    v_and_b32 v3, 3, v0
    v_lshrrev_b32 v4, 2, v0
    s_lshl_b32 s16, s14, 18
    s_lshl_b32 s17, s15, 6
    s_add_u32 s16, s16, s17
    v_lshlrev_b32 v5, 10, v4
    v_lshl_add_u32 v5, v3, 4, v5
    v_add_u32 v5, s16, v5
    s_waitcnt lgkmcnt(0)
    global_load_dwordx4 v[16:19], v5, s[6:7]
    v_add_u32 v5, 0x10000, v5
    global_load_dwordx4 v[20:23], v5, s[6:7]
    v_add_u32 v5, 0x10000, v5
    global_load_dwordx4 v[24:27], v5, s[6:7]
    v_add_u32 v5, 0x10000, v5
    global_load_dwordx4 v[28:31], v5, s[6:7]
    v_lshrrev_b32 v6, 7, v0
    s_lshl_b32 s18, s14, 1
    v_add_u32 v6, s18, v6
    v_and_b32 v7, 127, v0
    v_lshlrev_b32 v8, 7, v6
    v_add_u32 v8, 32768, v8
    global_load_dwordx4 v[32:35], v8, s[8:9] offset:0
    global_load_dwordx4 v[36:39], v8, s[8:9] offset:16
    global_load_dwordx4 v[40:43], v8, s[8:9] offset:32
    global_load_dwordx4 v[44:47], v8, s[8:9] offset:48
    global_load_dwordx4 v[48:51], v8, s[8:9] offset:64
    global_load_dwordx4 v[52:55], v8, s[8:9] offset:80
    global_load_dwordx4 v[56:59], v8, s[8:9] offset:96
    global_load_dwordx4 v[60:63], v8, s[8:9] offset:112
    v_lshlrev_b32 v9, 13, v6
    v_lshl_add_u32 v9, v7, 2, v9
    v_add_u32 v9, 65536, v9
    v_add_u32 v10, 4096, v9
    global_load_dword v64, v9, s[8:9] offset:0
    global_load_dword v65, v9, s[8:9] offset:512
    global_load_dword v66, v9, s[8:9] offset:1024
    global_load_dword v67, v9, s[8:9] offset:1536
    global_load_dword v68, v9, s[8:9] offset:2048
    global_load_dword v69, v9, s[8:9] offset:2560
    global_load_dword v70, v9, s[8:9] offset:3072
    global_load_dword v71, v9, s[8:9] offset:3584
    global_load_dword v72, v10, s[8:9] offset:0
    global_load_dword v73, v10, s[8:9] offset:512
    global_load_dword v74, v10, s[8:9] offset:1024
    global_load_dword v75, v10, s[8:9] offset:1536
    global_load_dword v76, v10, s[8:9] offset:2048
    global_load_dword v77, v10, s[8:9] offset:2560
    global_load_dword v78, v10, s[8:9] offset:3072
    global_load_dword v79, v10, s[8:9] offset:3584
    s_waitcnt vmcnt(16)
    v_max_f32 v80, v32, v34
    v_max_f32 v80, v80, v36
    v_max_f32 v80, v80, v38
    v_max_f32 v80, v80, v40
    v_max_f32 v80, v80, v42
    v_max_f32 v80, v80, v44
    v_max_f32 v80, v80, v46
    v_max_f32 v80, v80, v48
    v_max_f32 v80, v80, v50
    v_max_f32 v80, v80, v52
    v_max_f32 v80, v80, v54
    v_max_f32 v80, v80, v56
    v_max_f32 v80, v80, v58
    v_max_f32 v80, v80, v60
    v_max_f32 v80, v80, v62
    v_sub_f32 v32, v32, v80
    v_exp_f32 v32, v32
    v_sub_f32 v34, v34, v80
    v_exp_f32 v34, v34
    v_sub_f32 v36, v36, v80
    v_exp_f32 v36, v36
    v_sub_f32 v38, v38, v80
    v_exp_f32 v38, v38
    v_sub_f32 v40, v40, v80
    v_exp_f32 v40, v40
    v_sub_f32 v42, v42, v80
    v_exp_f32 v42, v42
    v_sub_f32 v44, v44, v80
    v_exp_f32 v44, v44
    v_sub_f32 v46, v46, v80
    v_exp_f32 v46, v46
    v_sub_f32 v48, v48, v80
    v_exp_f32 v48, v48
    v_sub_f32 v50, v50, v80
    v_exp_f32 v50, v50
    v_sub_f32 v52, v52, v80
    v_exp_f32 v52, v52
    v_sub_f32 v54, v54, v80
    v_exp_f32 v54, v54
    v_sub_f32 v56, v56, v80
    v_exp_f32 v56, v56
    v_sub_f32 v58, v58, v80
    v_exp_f32 v58, v58
    v_sub_f32 v60, v60, v80
    v_exp_f32 v60, v60
    v_sub_f32 v62, v62, v80
    v_exp_f32 v62, v62
    s_nop 0
    v_mul_f32 v81, v32, v33
    v_fmac_f32 v81, v34, v35
    v_fmac_f32 v81, v36, v37
    v_fmac_f32 v81, v38, v39
    v_fmac_f32 v81, v40, v41
    v_fmac_f32 v81, v42, v43
    v_fmac_f32 v81, v44, v45
    v_fmac_f32 v81, v46, v47
    v_fmac_f32 v81, v48, v49
    v_fmac_f32 v81, v50, v51
    v_fmac_f32 v81, v52, v53
    v_fmac_f32 v81, v54, v55
    v_fmac_f32 v81, v56, v57
    v_fmac_f32 v81, v58, v59
    v_fmac_f32 v81, v60, v61
    v_fmac_f32 v81, v62, v63
    v_rcp_f32 v81, v81
    s_waitcnt vmcnt(0)
    v_mul_f32 v82, v32, v64
    v_fmac_f32 v82, v34, v65
    v_fmac_f32 v82, v36, v66
    v_fmac_f32 v82, v38, v67
    v_fmac_f32 v82, v40, v68
    v_fmac_f32 v82, v42, v69
    v_fmac_f32 v82, v44, v70
    v_fmac_f32 v82, v46, v71
    v_fmac_f32 v82, v48, v72
    v_fmac_f32 v82, v50, v73
    v_fmac_f32 v82, v52, v74
    v_fmac_f32 v82, v54, v75
    v_fmac_f32 v82, v56, v76
    v_fmac_f32 v82, v58, v77
    v_fmac_f32 v82, v60, v78
    v_fmac_f32 v82, v62, v79
    v_mul_f32 v82, v82, v81
    v_cvt_pk_bf16_f32 v82, v82, v82
    v_lshlrev_b32 v82, 16, v82
    v_lshlrev_b32 v11, 3, v0
    ds_write_b32 v11, v82 offset:0
    v_lshlrev_b32 v8, 7, v6
    v_add_u32 v8, 36864, v8
    global_load_dwordx4 v[32:35], v8, s[8:9] offset:0
    global_load_dwordx4 v[36:39], v8, s[8:9] offset:16
    global_load_dwordx4 v[40:43], v8, s[8:9] offset:32
    global_load_dwordx4 v[44:47], v8, s[8:9] offset:48
    global_load_dwordx4 v[48:51], v8, s[8:9] offset:64
    global_load_dwordx4 v[52:55], v8, s[8:9] offset:80
    global_load_dwordx4 v[56:59], v8, s[8:9] offset:96
    global_load_dwordx4 v[60:63], v8, s[8:9] offset:112
    v_lshlrev_b32 v9, 13, v6
    v_lshl_add_u32 v9, v7, 2, v9
    v_add_u32 v9, 327680, v9
    v_add_u32 v10, 4096, v9
    global_load_dword v64, v9, s[8:9] offset:0
    global_load_dword v65, v9, s[8:9] offset:512
    global_load_dword v66, v9, s[8:9] offset:1024
    global_load_dword v67, v9, s[8:9] offset:1536
    global_load_dword v68, v9, s[8:9] offset:2048
    global_load_dword v69, v9, s[8:9] offset:2560
    global_load_dword v70, v9, s[8:9] offset:3072
    global_load_dword v71, v9, s[8:9] offset:3584
    global_load_dword v72, v10, s[8:9] offset:0
    global_load_dword v73, v10, s[8:9] offset:512
    global_load_dword v74, v10, s[8:9] offset:1024
    global_load_dword v75, v10, s[8:9] offset:1536
    global_load_dword v76, v10, s[8:9] offset:2048
    global_load_dword v77, v10, s[8:9] offset:2560
    global_load_dword v78, v10, s[8:9] offset:3072
    global_load_dword v79, v10, s[8:9] offset:3584
    s_waitcnt vmcnt(16)
    v_max_f32 v80, v32, v34
    v_max_f32 v80, v80, v36
    v_max_f32 v80, v80, v38
    v_max_f32 v80, v80, v40
    v_max_f32 v80, v80, v42
    v_max_f32 v80, v80, v44
    v_max_f32 v80, v80, v46
    v_max_f32 v80, v80, v48
    v_max_f32 v80, v80, v50
    v_max_f32 v80, v80, v52
    v_max_f32 v80, v80, v54
    v_max_f32 v80, v80, v56
    v_max_f32 v80, v80, v58
    v_max_f32 v80, v80, v60
    v_max_f32 v80, v80, v62
    v_sub_f32 v32, v32, v80
    v_exp_f32 v32, v32
    v_sub_f32 v34, v34, v80
    v_exp_f32 v34, v34
    v_sub_f32 v36, v36, v80
    v_exp_f32 v36, v36
    v_sub_f32 v38, v38, v80
    v_exp_f32 v38, v38
    v_sub_f32 v40, v40, v80
    v_exp_f32 v40, v40
    v_sub_f32 v42, v42, v80
    v_exp_f32 v42, v42
    v_sub_f32 v44, v44, v80
    v_exp_f32 v44, v44
    v_sub_f32 v46, v46, v80
    v_exp_f32 v46, v46
    v_sub_f32 v48, v48, v80
    v_exp_f32 v48, v48
    v_sub_f32 v50, v50, v80
    v_exp_f32 v50, v50
    v_sub_f32 v52, v52, v80
    v_exp_f32 v52, v52
    v_sub_f32 v54, v54, v80
    v_exp_f32 v54, v54
    v_sub_f32 v56, v56, v80
    v_exp_f32 v56, v56
    v_sub_f32 v58, v58, v80
    v_exp_f32 v58, v58
    v_sub_f32 v60, v60, v80
    v_exp_f32 v60, v60
    v_sub_f32 v62, v62, v80
    v_exp_f32 v62, v62
    s_nop 0
    v_mul_f32 v81, v32, v33
    v_fmac_f32 v81, v34, v35
    v_fmac_f32 v81, v36, v37
    v_fmac_f32 v81, v38, v39
    v_fmac_f32 v81, v40, v41
    v_fmac_f32 v81, v42, v43
    v_fmac_f32 v81, v44, v45
    v_fmac_f32 v81, v46, v47
    v_fmac_f32 v81, v48, v49
    v_fmac_f32 v81, v50, v51
    v_fmac_f32 v81, v52, v53
    v_fmac_f32 v81, v54, v55
    v_fmac_f32 v81, v56, v57
    v_fmac_f32 v81, v58, v59
    v_fmac_f32 v81, v60, v61
    v_fmac_f32 v81, v62, v63
    v_rcp_f32 v81, v81
    s_waitcnt vmcnt(0)
    v_mul_f32 v82, v32, v64
    v_fmac_f32 v82, v34, v65
    v_fmac_f32 v82, v36, v66
    v_fmac_f32 v82, v38, v67
    v_fmac_f32 v82, v40, v68
    v_fmac_f32 v82, v42, v69
    v_fmac_f32 v82, v44, v70
    v_fmac_f32 v82, v46, v71
    v_fmac_f32 v82, v48, v72
    v_fmac_f32 v82, v50, v73
    v_fmac_f32 v82, v52, v74
    v_fmac_f32 v82, v54, v75
    v_fmac_f32 v82, v56, v76
    v_fmac_f32 v82, v58, v77
    v_fmac_f32 v82, v60, v78
    v_fmac_f32 v82, v62, v79
    v_mul_f32 v82, v82, v81
    v_cvt_pk_bf16_f32 v82, v82, v82
    v_lshlrev_b32 v82, 16, v82
    v_lshlrev_b32 v11, 3, v0
    ds_write_b32 v11, v82 offset:4
    s_waitcnt lgkmcnt(0)
    s_barrier
    v_lshlrev_b32 v11, 3, v4
    ds_read_b64 v[64:65], v11 offset:0
    ds_read_b64 v[66:67], v11 offset:512
    ds_read_b64 v[68:69], v11 offset:1024
    ds_read_b64 v[70:71], v11 offset:1536
    v_mov_b32 v80, 0
    v_mov_b32 v81, 0
    v_mov_b32 v82, 0
    v_mov_b32 v83, 0
    v_mov_b32 v84, 0
    v_mov_b32 v85, 0
    v_mov_b32 v86, 0
    v_mov_b32 v87, 0
    v_mov_b32 v88, 0
    v_mov_b32 v89, 0
    v_mov_b32 v90, 0
    v_mov_b32 v91, 0
    v_mov_b32 v92, 0
    v_mov_b32 v93, 0
    v_mov_b32 v94, 0
    v_mov_b32 v95, 0
    s_waitcnt lgkmcnt(0)
    v_lshlrev_b32 v32, 16, v16
    v_and_b32 v33, 0xffff0000, v16
    v_fmac_f32 v80, v64, v32
    v_fmac_f32 v81, v64, v33
    v_fmac_f32 v88, v65, v32
    v_fmac_f32 v89, v65, v33
    v_lshlrev_b32 v32, 16, v17
    v_and_b32 v33, 0xffff0000, v17
    v_fmac_f32 v82, v64, v32
    v_fmac_f32 v83, v64, v33
    v_fmac_f32 v90, v65, v32
    v_fmac_f32 v91, v65, v33
    v_lshlrev_b32 v32, 16, v18
    v_and_b32 v33, 0xffff0000, v18
    v_fmac_f32 v84, v64, v32
    v_fmac_f32 v85, v64, v33
    v_fmac_f32 v92, v65, v32
    v_fmac_f32 v93, v65, v33
    v_lshlrev_b32 v32, 16, v19
    v_and_b32 v33, 0xffff0000, v19
    v_fmac_f32 v86, v64, v32
    v_fmac_f32 v87, v64, v33
    v_fmac_f32 v94, v65, v32
    v_fmac_f32 v95, v65, v33
    v_lshlrev_b32 v32, 16, v20
    v_and_b32 v33, 0xffff0000, v20
    v_fmac_f32 v80, v66, v32
    v_fmac_f32 v81, v66, v33
    v_fmac_f32 v88, v67, v32
    v_fmac_f32 v89, v67, v33
    v_lshlrev_b32 v32, 16, v21
    v_and_b32 v33, 0xffff0000, v21
    v_fmac_f32 v82, v66, v32
    v_fmac_f32 v83, v66, v33
    v_fmac_f32 v90, v67, v32
    v_fmac_f32 v91, v67, v33
    v_lshlrev_b32 v32, 16, v22
    v_and_b32 v33, 0xffff0000, v22
    v_fmac_f32 v84, v66, v32
    v_fmac_f32 v85, v66, v33
    v_fmac_f32 v92, v67, v32
    v_fmac_f32 v93, v67, v33
    v_lshlrev_b32 v32, 16, v23
    v_and_b32 v33, 0xffff0000, v23
    v_fmac_f32 v86, v66, v32
    v_fmac_f32 v87, v66, v33
    v_fmac_f32 v94, v67, v32
    v_fmac_f32 v95, v67, v33
    v_lshlrev_b32 v32, 16, v24
    v_and_b32 v33, 0xffff0000, v24
    v_fmac_f32 v80, v68, v32
    v_fmac_f32 v81, v68, v33
    v_fmac_f32 v88, v69, v32
    v_fmac_f32 v89, v69, v33
    v_lshlrev_b32 v32, 16, v25
    v_and_b32 v33, 0xffff0000, v25
    v_fmac_f32 v82, v68, v32
    v_fmac_f32 v83, v68, v33
    v_fmac_f32 v90, v69, v32
    v_fmac_f32 v91, v69, v33
    v_lshlrev_b32 v32, 16, v26
    v_and_b32 v33, 0xffff0000, v26
    v_fmac_f32 v84, v68, v32
    v_fmac_f32 v85, v68, v33
    v_fmac_f32 v92, v69, v32
    v_fmac_f32 v93, v69, v33
    v_lshlrev_b32 v32, 16, v27
    v_and_b32 v33, 0xffff0000, v27
    v_fmac_f32 v86, v68, v32
    v_fmac_f32 v87, v68, v33
    v_fmac_f32 v94, v69, v32
    v_fmac_f32 v95, v69, v33
    v_lshlrev_b32 v32, 16, v28
    v_and_b32 v33, 0xffff0000, v28
    v_fmac_f32 v80, v70, v32
    v_fmac_f32 v81, v70, v33
    v_fmac_f32 v88, v71, v32
    v_fmac_f32 v89, v71, v33
    v_lshlrev_b32 v32, 16, v29
    v_and_b32 v33, 0xffff0000, v29
    v_fmac_f32 v82, v70, v32
    v_fmac_f32 v83, v70, v33
    v_fmac_f32 v90, v71, v32
    v_fmac_f32 v91, v71, v33
    v_lshlrev_b32 v32, 16, v30
    v_and_b32 v33, 0xffff0000, v30
    v_fmac_f32 v84, v70, v32
    v_fmac_f32 v85, v70, v33
    v_fmac_f32 v92, v71, v32
    v_fmac_f32 v93, v71, v33
    v_lshlrev_b32 v32, 16, v31
    v_and_b32 v33, 0xffff0000, v31
    v_fmac_f32 v86, v70, v32
    v_fmac_f32 v87, v70, v33
    v_fmac_f32 v94, v71, v32
    v_fmac_f32 v95, v71, v33
    s_nop 1
    v_add_f32_dpp v80, v80, v80 row_ror:4 row_mask:0xf bank_mask:0xf
    v_add_f32_dpp v81, v81, v81 row_ror:4 row_mask:0xf bank_mask:0xf
    v_add_f32_dpp v82, v82, v82 row_ror:4 row_mask:0xf bank_mask:0xf
    v_add_f32_dpp v83, v83, v83 row_ror:4 row_mask:0xf bank_mask:0xf
    v_add_f32_dpp v84, v84, v84 row_ror:4 row_mask:0xf bank_mask:0xf
    v_add_f32_dpp v85, v85, v85 row_ror:4 row_mask:0xf bank_mask:0xf
    v_add_f32_dpp v86, v86, v86 row_ror:4 row_mask:0xf bank_mask:0xf
    v_add_f32_dpp v87, v87, v87 row_ror:4 row_mask:0xf bank_mask:0xf
    v_add_f32_dpp v88, v88, v88 row_ror:4 row_mask:0xf bank_mask:0xf
    v_add_f32_dpp v89, v89, v89 row_ror:4 row_mask:0xf bank_mask:0xf
    v_add_f32_dpp v90, v90, v90 row_ror:4 row_mask:0xf bank_mask:0xf
    v_add_f32_dpp v91, v91, v91 row_ror:4 row_mask:0xf bank_mask:0xf
    v_add_f32_dpp v92, v92, v92 row_ror:4 row_mask:0xf bank_mask:0xf
    v_add_f32_dpp v93, v93, v93 row_ror:4 row_mask:0xf bank_mask:0xf
    v_add_f32_dpp v94, v94, v94 row_ror:4 row_mask:0xf bank_mask:0xf
    v_add_f32_dpp v95, v95, v95 row_ror:4 row_mask:0xf bank_mask:0xf
    s_nop 1
    v_add_f32_dpp v80, v80, v80 row_ror:8 row_mask:0xf bank_mask:0xf
    v_add_f32_dpp v81, v81, v81 row_ror:8 row_mask:0xf bank_mask:0xf
    v_add_f32_dpp v82, v82, v82 row_ror:8 row_mask:0xf bank_mask:0xf
    v_add_f32_dpp v83, v83, v83 row_ror:8 row_mask:0xf bank_mask:0xf
    v_add_f32_dpp v84, v84, v84 row_ror:8 row_mask:0xf bank_mask:0xf
    v_add_f32_dpp v85, v85, v85 row_ror:8 row_mask:0xf bank_mask:0xf
    v_add_f32_dpp v86, v86, v86 row_ror:8 row_mask:0xf bank_mask:0xf
    v_add_f32_dpp v87, v87, v87 row_ror:8 row_mask:0xf bank_mask:0xf
    v_add_f32_dpp v88, v88, v88 row_ror:8 row_mask:0xf bank_mask:0xf
    v_add_f32_dpp v89, v89, v89 row_ror:8 row_mask:0xf bank_mask:0xf
    v_add_f32_dpp v90, v90, v90 row_ror:8 row_mask:0xf bank_mask:0xf
    v_add_f32_dpp v91, v91, v91 row_ror:8 row_mask:0xf bank_mask:0xf
    v_add_f32_dpp v92, v92, v92 row_ror:8 row_mask:0xf bank_mask:0xf
    v_add_f32_dpp v93, v93, v93 row_ror:8 row_mask:0xf bank_mask:0xf
    v_add_f32_dpp v94, v94, v94 row_ror:8 row_mask:0xf bank_mask:0xf
    v_add_f32_dpp v95, v95, v95 row_ror:8 row_mask:0xf bank_mask:0xf
    v_mov_b32 v34, v80
    s_nop 1
    v_permlane16_swap_b32 v80, v34
    s_nop 1
    v_add_f32 v80, v80, v34
    v_mov_b32 v34, v81
    s_nop 1
    v_permlane16_swap_b32 v81, v34
    s_nop 1
    v_add_f32 v81, v81, v34
    v_mov_b32 v34, v82
    s_nop 1
    v_permlane16_swap_b32 v82, v34
    s_nop 1
    v_add_f32 v82, v82, v34
    v_mov_b32 v34, v83
    s_nop 1
    v_permlane16_swap_b32 v83, v34
    s_nop 1
    v_add_f32 v83, v83, v34
    v_mov_b32 v34, v84
    s_nop 1
    v_permlane16_swap_b32 v84, v34
    s_nop 1
    v_add_f32 v84, v84, v34
    v_mov_b32 v34, v85
    s_nop 1
    v_permlane16_swap_b32 v85, v34
    s_nop 1
    v_add_f32 v85, v85, v34
    v_mov_b32 v34, v86
    s_nop 1
    v_permlane16_swap_b32 v86, v34
    s_nop 1
    v_add_f32 v86, v86, v34
    v_mov_b32 v34, v87
    s_nop 1
    v_permlane16_swap_b32 v87, v34
    s_nop 1
    v_add_f32 v87, v87, v34
    v_mov_b32 v34, v88
    s_nop 1
    v_permlane16_swap_b32 v88, v34
    s_nop 1
    v_add_f32 v88, v88, v34
    v_mov_b32 v34, v89
    s_nop 1
    v_permlane16_swap_b32 v89, v34
    s_nop 1
    v_add_f32 v89, v89, v34
    v_mov_b32 v34, v90
    s_nop 1
    v_permlane16_swap_b32 v90, v34
    s_nop 1
    v_add_f32 v90, v90, v34
    v_mov_b32 v34, v91
    s_nop 1
    v_permlane16_swap_b32 v91, v34
    s_nop 1
    v_add_f32 v91, v91, v34
    v_mov_b32 v34, v92
    s_nop 1
    v_permlane16_swap_b32 v92, v34
    s_nop 1
    v_add_f32 v92, v92, v34
    v_mov_b32 v34, v93
    s_nop 1
    v_permlane16_swap_b32 v93, v34
    s_nop 1
    v_add_f32 v93, v93, v34
    v_mov_b32 v34, v94
    s_nop 1
    v_permlane16_swap_b32 v94, v34
    s_nop 1
    v_add_f32 v94, v94, v34
    v_mov_b32 v34, v95
    s_nop 1
    v_permlane16_swap_b32 v95, v34
    s_nop 1
    v_add_f32 v95, v95, v34
    v_mov_b32 v34, v80
    s_nop 1
    v_permlane32_swap_b32 v80, v34
    s_nop 1
    v_add_f32 v80, v80, v34
    v_mov_b32 v34, v81
    s_nop 1
    v_permlane32_swap_b32 v81, v34
    s_nop 1
    v_add_f32 v81, v81, v34
    v_mov_b32 v34, v82
    s_nop 1
    v_permlane32_swap_b32 v82, v34
    s_nop 1
    v_add_f32 v82, v82, v34
    v_mov_b32 v34, v83
    s_nop 1
    v_permlane32_swap_b32 v83, v34
    s_nop 1
    v_add_f32 v83, v83, v34
    v_mov_b32 v34, v84
    s_nop 1
    v_permlane32_swap_b32 v84, v34
    s_nop 1
    v_add_f32 v84, v84, v34
    v_mov_b32 v34, v85
    s_nop 1
    v_permlane32_swap_b32 v85, v34
    s_nop 1
    v_add_f32 v85, v85, v34
    v_mov_b32 v34, v86
    s_nop 1
    v_permlane32_swap_b32 v86, v34
    s_nop 1
    v_add_f32 v86, v86, v34
    v_mov_b32 v34, v87
    s_nop 1
    v_permlane32_swap_b32 v87, v34
    s_nop 1
    v_add_f32 v87, v87, v34
    v_mov_b32 v34, v88
    s_nop 1
    v_permlane32_swap_b32 v88, v34
    s_nop 1
    v_add_f32 v88, v88, v34
    v_mov_b32 v34, v89
    s_nop 1
    v_permlane32_swap_b32 v89, v34
    s_nop 1
    v_add_f32 v89, v89, v34
    v_mov_b32 v34, v90
    s_nop 1
    v_permlane32_swap_b32 v90, v34
    s_nop 1
    v_add_f32 v90, v90, v34
    v_mov_b32 v34, v91
    s_nop 1
    v_permlane32_swap_b32 v91, v34
    s_nop 1
    v_add_f32 v91, v91, v34
    v_mov_b32 v34, v92
    s_nop 1
    v_permlane32_swap_b32 v92, v34
    s_nop 1
    v_add_f32 v92, v92, v34
    v_mov_b32 v34, v93
    s_nop 1
    v_permlane32_swap_b32 v93, v34
    s_nop 1
    v_add_f32 v93, v93, v34
    v_mov_b32 v34, v94
    s_nop 1
    v_permlane32_swap_b32 v94, v34
    s_nop 1
    v_add_f32 v94, v94, v34
    v_mov_b32 v34, v95
    s_nop 1
    v_permlane32_swap_b32 v95, v34
    s_nop 1
    v_add_f32 v95, v95, v34
    v_lshlrev_b32 v23, 8, v2
    v_lshl_add_u32 v23, v3, 6, v23
    v_add_u32 v23, 4096, v23
    v_cmp_gt_u32 vcc, 4, v1
    s_and_saveexec_b64 s[10:11], vcc
    ds_write_b128 v23, v[80:83] offset:0
    ds_write_b128 v23, v[84:87] offset:16
    ds_write_b128 v23, v[88:91] offset:32
    ds_write_b128 v23, v[92:95] offset:48
    s_mov_b64 exec, s[10:11]
    s_waitcnt lgkmcnt(0)
    s_barrier
    v_cmp_gt_u32 vcc, 64, v0
    s_and_saveexec_b64 s[10:11], vcc
    s_cbranch_execz k3_oproj_kernel_end
    v_lshrrev_b32 v24, 5, v0
    v_and_b32 v25, 31, v0
    v_lshrrev_b32 v26, 3, v25
    v_and_b32 v27, 7, v25
    v_lshlrev_b32 v28, 6, v26
    v_lshl_add_u32 v28, v24, 5, v28
    v_lshl_add_u32 v28, v27, 2, v28
    v_add_u32 v28, 4096, v28
    ds_read_b32 v30, v28 offset:0
    ds_read_b32 v31, v28 offset:256
    ds_read_b32 v32, v28 offset:512
    ds_read_b32 v33, v28 offset:768
    s_waitcnt lgkmcnt(0)
    v_add_f32 v30, v30, v31
    v_add_f32 v32, v32, v33
    v_add_f32 v30, v30, v32
    s_lshl_b32 s16, s14, 12
    s_lshl_b32 s17, s15, 7
    s_add_u32 s16, s16, s17
    s_add_u32 s16, s16, 589824
    v_lshlrev_b32 v28, 11, v24
    v_lshl_add_u32 v28, v25, 2, v28
    v_add_u32 v28, s16, v28
    global_store_dword v28, v30, s[8:9]
k3_oproj_kernel_end:
    s_endpgm
.globl k4_mlp_kernel
.p2align 8
.type k4_mlp_kernel,@function
k4_mlp_kernel:
    s_cmp_ge_u32 s2, 112
    s_cbranch_scc1 k4_mlp_kernel_end
    s_load_dwordx2 s[4:5], s[0:1], 0
    s_load_dwordx2 s[6:7], s[0:1], 48
    s_load_dwordx2 s[10:11], s[0:1], 56
    s_load_dwordx2 s[12:13], s[0:1], 64
    s_load_dwordx2 s[8:9], s[0:1], 88
    v_and_b32 v1, 63, v0
    v_lshrrev_b32 v2, 6, v0
    v_and_b32 v3, 1, v0
    v_lshrrev_b32 v4, 1, v0
    s_mov_b32 s3, 3584
    v_mul_lo_u32 v5, v4, s3
    v_lshl_add_u32 v5, v3, 4, v5
    s_lshl_b32 s16, s2, 5
    v_add_u32 v5, s16, v5
    v_and_b32 v6, 1, v2
    s_waitcnt lgkmcnt(0)
    global_load_dwordx4 v[96:99], v5, s[6:7]
    global_load_dwordx4 v[112:115], v5, s[10:11]
    v_add_u32 v5, 458752, v5
    global_load_dwordx4 v[100:103], v5, s[6:7]
    global_load_dwordx4 v[116:119], v5, s[10:11]
    v_add_u32 v5, 458752, v5
    global_load_dwordx4 v[104:107], v5, s[6:7]
    global_load_dwordx4 v[120:123], v5, s[10:11]
    v_add_u32 v5, 458752, v5
    global_load_dwordx4 v[108:111], v5, s[6:7]
    global_load_dwordx4 v[124:127], v5, s[10:11]
    s_lshl_b32 s17, s2, 14
    v_lshlrev_b32 v7, 2, v0
    v_add_u32 v7, s17, v7
    v_add_u32 v8, 4096, v7
    v_add_u32 v9, 8192, v7
    v_add_u32 v10, 12288, v7
    global_load_dword v128, v7, s[12:13] offset:0
    global_load_dword v129, v7, s[12:13] offset:1024
    global_load_dword v130, v7, s[12:13] offset:2048
    global_load_dword v131, v7, s[12:13] offset:3072
    global_load_dword v132, v8, s[12:13] offset:0
    global_load_dword v133, v8, s[12:13] offset:1024
    global_load_dword v134, v8, s[12:13] offset:2048
    global_load_dword v135, v8, s[12:13] offset:3072
    global_load_dword v136, v9, s[12:13] offset:0
    global_load_dword v137, v9, s[12:13] offset:1024
    global_load_dword v138, v9, s[12:13] offset:2048
    global_load_dword v139, v9, s[12:13] offset:3072
    global_load_dword v140, v10, s[12:13] offset:0
    global_load_dword v141, v10, s[12:13] offset:1024
    global_load_dword v142, v10, s[12:13] offset:2048
    global_load_dword v143, v10, s[12:13] offset:3072
    v_lshlrev_b32 v11, 10, v6
    v_lshl_add_u32 v11, v1, 4, v11
    global_load_dwordx4 v[12:15], v11, s[4:5]
    v_lshlrev_b32 v11, 11, v6
    v_lshl_add_u32 v11, v1, 5, v11
    v_add_u32 v11, 589824, v11
    global_load_dwordx4 v[32:35], v11, s[8:9]
    global_load_dwordx4 v[36:39], v11, s[8:9] offset:16
    v_add_u32 v11, 4096, v11
    global_load_dwordx4 v[40:43], v11, s[8:9]
    global_load_dwordx4 v[44:47], v11, s[8:9] offset:16
    v_add_u32 v11, 4096, v11
    global_load_dwordx4 v[48:51], v11, s[8:9]
    global_load_dwordx4 v[52:55], v11, s[8:9] offset:16
    v_add_u32 v11, 4096, v11
    global_load_dwordx4 v[56:59], v11, s[8:9]
    global_load_dwordx4 v[60:63], v11, s[8:9] offset:16
    s_waitcnt vmcnt(0)
    v_add_f32 v24, v32, v40
    v_add_f32 v48, v48, v56
    v_add_f32 v24, v24, v48
    v_add_f32 v25, v33, v41
    v_add_f32 v49, v49, v57
    v_add_f32 v25, v25, v49
    v_add_f32 v26, v34, v42
    v_add_f32 v50, v50, v58
    v_add_f32 v26, v26, v50
    v_add_f32 v27, v35, v43
    v_add_f32 v51, v51, v59
    v_add_f32 v27, v27, v51
    v_add_f32 v28, v36, v44
    v_add_f32 v52, v52, v60
    v_add_f32 v28, v28, v52
    v_add_f32 v29, v37, v45
    v_add_f32 v53, v53, v61
    v_add_f32 v29, v29, v53
    v_add_f32 v30, v38, v46
    v_add_f32 v54, v54, v62
    v_add_f32 v30, v30, v54
    v_add_f32 v31, v39, v47
    v_add_f32 v55, v55, v63
    v_add_f32 v31, v31, v55
    v_add_u32 v11, 4096, v11
    global_load_dwordx4 v[32:35], v11, s[8:9]
    global_load_dwordx4 v[36:39], v11, s[8:9] offset:16
    v_add_u32 v11, 4096, v11
    global_load_dwordx4 v[40:43], v11, s[8:9]
    global_load_dwordx4 v[44:47], v11, s[8:9] offset:16
    v_add_u32 v11, 4096, v11
    global_load_dwordx4 v[48:51], v11, s[8:9]
    global_load_dwordx4 v[52:55], v11, s[8:9] offset:16
    v_add_u32 v11, 4096, v11
    global_load_dwordx4 v[56:59], v11, s[8:9]
    global_load_dwordx4 v[60:63], v11, s[8:9] offset:16
    s_waitcnt vmcnt(0)
    v_add_f32 v24, v24, v32
    v_add_f32 v24, v24, v40
    v_add_f32 v48, v48, v56
    v_add_f32 v24, v24, v48
    v_add_f32 v25, v25, v33
    v_add_f32 v25, v25, v41
    v_add_f32 v49, v49, v57
    v_add_f32 v25, v25, v49
    v_add_f32 v26, v26, v34
    v_add_f32 v26, v26, v42
    v_add_f32 v50, v50, v58
    v_add_f32 v26, v26, v50
    v_add_f32 v27, v27, v35
    v_add_f32 v27, v27, v43
    v_add_f32 v51, v51, v59
    v_add_f32 v27, v27, v51
    v_add_f32 v28, v28, v36
    v_add_f32 v28, v28, v44
    v_add_f32 v52, v52, v60
    v_add_f32 v28, v28, v52
    v_add_f32 v29, v29, v37
    v_add_f32 v29, v29, v45
    v_add_f32 v53, v53, v61
    v_add_f32 v29, v29, v53
    v_add_f32 v30, v30, v38
    v_add_f32 v30, v30, v46
    v_add_f32 v54, v54, v62
    v_add_f32 v30, v30, v54
    v_add_f32 v31, v31, v39
    v_add_f32 v31, v31, v47
    v_add_f32 v55, v55, v63
    v_add_f32 v31, v31, v55
    v_add_u32 v11, 4096, v11
    global_load_dwordx4 v[32:35], v11, s[8:9]
    global_load_dwordx4 v[36:39], v11, s[8:9] offset:16
    v_add_u32 v11, 4096, v11
    global_load_dwordx4 v[40:43], v11, s[8:9]
    global_load_dwordx4 v[44:47], v11, s[8:9] offset:16
    v_add_u32 v11, 4096, v11
    global_load_dwordx4 v[48:51], v11, s[8:9]
    global_load_dwordx4 v[52:55], v11, s[8:9] offset:16
    v_add_u32 v11, 4096, v11
    global_load_dwordx4 v[56:59], v11, s[8:9]
    global_load_dwordx4 v[60:63], v11, s[8:9] offset:16
    s_waitcnt vmcnt(0)
    v_add_f32 v24, v24, v32
    v_add_f32 v24, v24, v40
    v_add_f32 v48, v48, v56
    v_add_f32 v24, v24, v48
    v_add_f32 v25, v25, v33
    v_add_f32 v25, v25, v41
    v_add_f32 v49, v49, v57
    v_add_f32 v25, v25, v49
    v_add_f32 v26, v26, v34
    v_add_f32 v26, v26, v42
    v_add_f32 v50, v50, v58
    v_add_f32 v26, v26, v50
    v_add_f32 v27, v27, v35
    v_add_f32 v27, v27, v43
    v_add_f32 v51, v51, v59
    v_add_f32 v27, v27, v51
    v_add_f32 v28, v28, v36
    v_add_f32 v28, v28, v44
    v_add_f32 v52, v52, v60
    v_add_f32 v28, v28, v52
    v_add_f32 v29, v29, v37
    v_add_f32 v29, v29, v45
    v_add_f32 v53, v53, v61
    v_add_f32 v29, v29, v53
    v_add_f32 v30, v30, v38
    v_add_f32 v30, v30, v46
    v_add_f32 v54, v54, v62
    v_add_f32 v30, v30, v54
    v_add_f32 v31, v31, v39
    v_add_f32 v31, v31, v47
    v_add_f32 v55, v55, v63
    v_add_f32 v31, v31, v55
    v_add_u32 v11, 4096, v11
    global_load_dwordx4 v[32:35], v11, s[8:9]
    global_load_dwordx4 v[36:39], v11, s[8:9] offset:16
    v_add_u32 v11, 4096, v11
    global_load_dwordx4 v[40:43], v11, s[8:9]
    global_load_dwordx4 v[44:47], v11, s[8:9] offset:16
    v_add_u32 v11, 4096, v11
    global_load_dwordx4 v[48:51], v11, s[8:9]
    global_load_dwordx4 v[52:55], v11, s[8:9] offset:16
    v_add_u32 v11, 4096, v11
    global_load_dwordx4 v[56:59], v11, s[8:9]
    global_load_dwordx4 v[60:63], v11, s[8:9] offset:16
    s_waitcnt vmcnt(0)
    v_add_f32 v24, v24, v32
    v_add_f32 v24, v24, v40
    v_add_f32 v48, v48, v56
    v_add_f32 v24, v24, v48
    v_add_f32 v25, v25, v33
    v_add_f32 v25, v25, v41
    v_add_f32 v49, v49, v57
    v_add_f32 v25, v25, v49
    v_add_f32 v26, v26, v34
    v_add_f32 v26, v26, v42
    v_add_f32 v50, v50, v58
    v_add_f32 v26, v26, v50
    v_add_f32 v27, v27, v35
    v_add_f32 v27, v27, v43
    v_add_f32 v51, v51, v59
    v_add_f32 v27, v27, v51
    v_add_f32 v28, v28, v36
    v_add_f32 v28, v28, v44
    v_add_f32 v52, v52, v60
    v_add_f32 v28, v28, v52
    v_add_f32 v29, v29, v37
    v_add_f32 v29, v29, v45
    v_add_f32 v53, v53, v61
    v_add_f32 v29, v29, v53
    v_add_f32 v30, v30, v38
    v_add_f32 v30, v30, v46
    v_add_f32 v54, v54, v62
    v_add_f32 v30, v30, v54
    v_add_f32 v31, v31, v39
    v_add_f32 v31, v31, v47
    v_add_f32 v55, v55, v63
    v_add_f32 v31, v31, v55
    v_lshlrev_b32 v16, 16, v12
    v_and_b32 v17, 0xffff0000, v12
    v_lshlrev_b32 v18, 16, v13
    v_and_b32 v19, 0xffff0000, v13
    v_lshlrev_b32 v20, 16, v14
    v_and_b32 v21, 0xffff0000, v14
    v_lshlrev_b32 v22, 16, v15
    v_and_b32 v23, 0xffff0000, v15
    v_cvt_pk_bf16_f32 v24, v24, v24
    v_lshlrev_b32 v24, 16, v24
    v_add_f32 v16, v16, v24
    v_cvt_pk_bf16_f32 v16, v16, v16
    v_lshlrev_b32 v16, 16, v16
    v_cvt_pk_bf16_f32 v25, v25, v25
    v_lshlrev_b32 v25, 16, v25
    v_add_f32 v17, v17, v25
    v_cvt_pk_bf16_f32 v17, v17, v17
    v_lshlrev_b32 v17, 16, v17
    v_cvt_pk_bf16_f32 v26, v26, v26
    v_lshlrev_b32 v26, 16, v26
    v_add_f32 v18, v18, v26
    v_cvt_pk_bf16_f32 v18, v18, v18
    v_lshlrev_b32 v18, 16, v18
    v_cvt_pk_bf16_f32 v27, v27, v27
    v_lshlrev_b32 v27, 16, v27
    v_add_f32 v19, v19, v27
    v_cvt_pk_bf16_f32 v19, v19, v19
    v_lshlrev_b32 v19, 16, v19
    v_cvt_pk_bf16_f32 v28, v28, v28
    v_lshlrev_b32 v28, 16, v28
    v_add_f32 v20, v20, v28
    v_cvt_pk_bf16_f32 v20, v20, v20
    v_lshlrev_b32 v20, 16, v20
    v_cvt_pk_bf16_f32 v29, v29, v29
    v_lshlrev_b32 v29, 16, v29
    v_add_f32 v21, v21, v29
    v_cvt_pk_bf16_f32 v21, v21, v21
    v_lshlrev_b32 v21, 16, v21
    v_cvt_pk_bf16_f32 v30, v30, v30
    v_lshlrev_b32 v30, 16, v30
    v_add_f32 v22, v22, v30
    v_cvt_pk_bf16_f32 v22, v22, v22
    v_lshlrev_b32 v22, 16, v22
    v_cvt_pk_bf16_f32 v31, v31, v31
    v_lshlrev_b32 v31, 16, v31
    v_add_f32 v23, v23, v31
    v_cvt_pk_bf16_f32 v23, v23, v23
    v_lshlrev_b32 v23, 16, v23
    v_add_f32 v24, v16, v17
    v_add_f32 v24, v24, v18
    v_add_f32 v24, v24, v19
    v_add_f32 v24, v24, v20
    v_add_f32 v24, v24, v21
    v_add_f32 v24, v24, v22
    v_add_f32 v24, v24, v23
    s_nop 1
    v_add_f32_dpp v24, v24, v24 row_ror:1 row_mask:0xf bank_mask:0xf
    s_nop 1
    v_add_f32_dpp v24, v24, v24 row_ror:2 row_mask:0xf bank_mask:0xf
    s_nop 1
    v_add_f32_dpp v24, v24, v24 row_ror:4 row_mask:0xf bank_mask:0xf
    s_nop 1
    v_add_f32_dpp v24, v24, v24 row_ror:8 row_mask:0xf bank_mask:0xf
    v_mov_b32 v25, v24
    s_nop 1
    v_permlane16_swap_b32 v24, v25
    s_nop 1
    v_add_f32 v24, v24, v25
    v_mov_b32 v25, v24
    s_nop 1
    v_permlane32_swap_b32 v24, v25
    s_nop 1
    v_add_f32 v24, v24, v25
    v_mul_f32 v24, 0x3b000000, v24
    v_sub_f32 v25, v16, v24
    v_mul_f32 v26, v25, v25
    v_sub_f32 v25, v17, v24
    v_fmac_f32 v26, v25, v25
    v_sub_f32 v25, v18, v24
    v_fmac_f32 v26, v25, v25
    v_sub_f32 v25, v19, v24
    v_fmac_f32 v26, v25, v25
    v_sub_f32 v25, v20, v24
    v_fmac_f32 v26, v25, v25
    v_sub_f32 v25, v21, v24
    v_fmac_f32 v26, v25, v25
    v_sub_f32 v25, v22, v24
    v_fmac_f32 v26, v25, v25
    v_sub_f32 v25, v23, v24
    v_fmac_f32 v26, v25, v25
    s_nop 1
    v_add_f32_dpp v26, v26, v26 row_ror:1 row_mask:0xf bank_mask:0xf
    s_nop 1
    v_add_f32_dpp v26, v26, v26 row_ror:2 row_mask:0xf bank_mask:0xf
    s_nop 1
    v_add_f32_dpp v26, v26, v26 row_ror:4 row_mask:0xf bank_mask:0xf
    s_nop 1
    v_add_f32_dpp v26, v26, v26 row_ror:8 row_mask:0xf bank_mask:0xf
    v_mov_b32 v25, v26
    s_nop 1
    v_permlane16_swap_b32 v26, v25
    s_nop 1
    v_add_f32 v26, v26, v25
    v_mov_b32 v25, v26
    s_nop 1
    v_permlane32_swap_b32 v26, v25
    s_nop 1
    v_add_f32 v26, v26, v25
    v_mul_f32 v26, 0x3b000000, v26
    v_cvt_pk_bf16_f32 v26, v26, v26
    v_lshlrev_b32 v26, 16, v26
    v_add_f32 v26, 0x3727c5ac, v26
    v_cvt_pk_bf16_f32 v26, v26, v26
    v_lshlrev_b32 v26, 16, v26
    v_sqrt_f32 v26, v26
    s_nop 0
    v_cvt_pk_bf16_f32 v26, v26, v26
    v_lshlrev_b32 v26, 16, v26
    v_rcp_f32 v26, v26
    v_cvt_pk_bf16_f32 v24, v24, v24
    v_lshlrev_b32 v24, 16, v24
    v_sub_f32 v16, v16, v24
    v_cvt_pk_bf16_f32 v16, v16, v16
    v_lshlrev_b32 v16, 16, v16
    v_mul_f32 v16, v16, v26
    v_cvt_pk_bf16_f32 v16, v16, v16
    v_lshlrev_b32 v16, 16, v16
    v_sub_f32 v17, v17, v24
    v_cvt_pk_bf16_f32 v17, v17, v17
    v_lshlrev_b32 v17, 16, v17
    v_mul_f32 v17, v17, v26
    v_cvt_pk_bf16_f32 v17, v17, v17
    v_lshlrev_b32 v17, 16, v17
    v_sub_f32 v18, v18, v24
    v_cvt_pk_bf16_f32 v18, v18, v18
    v_lshlrev_b32 v18, 16, v18
    v_mul_f32 v18, v18, v26
    v_cvt_pk_bf16_f32 v18, v18, v18
    v_lshlrev_b32 v18, 16, v18
    v_sub_f32 v19, v19, v24
    v_cvt_pk_bf16_f32 v19, v19, v19
    v_lshlrev_b32 v19, 16, v19
    v_mul_f32 v19, v19, v26
    v_cvt_pk_bf16_f32 v19, v19, v19
    v_lshlrev_b32 v19, 16, v19
    v_sub_f32 v20, v20, v24
    v_cvt_pk_bf16_f32 v20, v20, v20
    v_lshlrev_b32 v20, 16, v20
    v_mul_f32 v20, v20, v26
    v_cvt_pk_bf16_f32 v20, v20, v20
    v_lshlrev_b32 v20, 16, v20
    v_sub_f32 v21, v21, v24
    v_cvt_pk_bf16_f32 v21, v21, v21
    v_lshlrev_b32 v21, 16, v21
    v_mul_f32 v21, v21, v26
    v_cvt_pk_bf16_f32 v21, v21, v21
    v_lshlrev_b32 v21, 16, v21
    v_sub_f32 v22, v22, v24
    v_cvt_pk_bf16_f32 v22, v22, v22
    v_lshlrev_b32 v22, 16, v22
    v_mul_f32 v22, v22, v26
    v_cvt_pk_bf16_f32 v22, v22, v22
    v_lshlrev_b32 v22, 16, v22
    v_sub_f32 v23, v23, v24
    v_cvt_pk_bf16_f32 v23, v23, v23
    v_lshlrev_b32 v23, 16, v23
    v_mul_f32 v23, v23, v26
    v_cvt_pk_bf16_f32 v23, v23, v23
    v_lshlrev_b32 v23, 16, v23
    v_lshlrev_b32 v27, 6, v1
    v_lshl_add_u32 v27, v6, 2, v27
    ds_write_b32 v27, v16 offset:0
    ds_write_b32 v27, v17 offset:8
    ds_write_b32 v27, v18 offset:16
    ds_write_b32 v27, v19 offset:24
    ds_write_b32 v27, v20 offset:32
    ds_write_b32 v27, v21 offset:40
    ds_write_b32 v27, v22 offset:48
    ds_write_b32 v27, v23 offset:56
    s_waitcnt lgkmcnt(0)
    s_barrier
    v_lshlrev_b32 v27, 3, v4
    ds_read_b64 v[64:65], v27 offset:0
    ds_read_b64 v[66:67], v27 offset:1024
    ds_read_b64 v[68:69], v27 offset:2048
    ds_read_b64 v[70:71], v27 offset:3072
    v_mov_b32 v144, 0
    v_mov_b32 v145, 0
    v_mov_b32 v146, 0
    v_mov_b32 v147, 0
    v_mov_b32 v148, 0
    v_mov_b32 v149, 0
    v_mov_b32 v150, 0
    v_mov_b32 v151, 0
    v_mov_b32 v152, 0
    v_mov_b32 v153, 0
    v_mov_b32 v154, 0
    v_mov_b32 v155, 0
    v_mov_b32 v156, 0
    v_mov_b32 v157, 0
    v_mov_b32 v158, 0
    v_mov_b32 v159, 0
    v_mov_b32 v160, 0
    v_mov_b32 v161, 0
    v_mov_b32 v162, 0
    v_mov_b32 v163, 0
    v_mov_b32 v164, 0
    v_mov_b32 v165, 0
    v_mov_b32 v166, 0
    v_mov_b32 v167, 0
    v_mov_b32 v168, 0
    v_mov_b32 v169, 0
    v_mov_b32 v170, 0
    v_mov_b32 v171, 0
    v_mov_b32 v172, 0
    v_mov_b32 v173, 0
    v_mov_b32 v174, 0
    v_mov_b32 v175, 0
    s_waitcnt lgkmcnt(0)
    v_lshlrev_b32 v28, 16, v96
    v_and_b32 v29, 0xffff0000, v96
    v_fmac_f32 v144, v64, v28
    v_fmac_f32 v145, v64, v29
    v_fmac_f32 v152, v65, v28
    v_fmac_f32 v153, v65, v29
    v_lshlrev_b32 v28, 16, v97
    v_and_b32 v29, 0xffff0000, v97
    v_fmac_f32 v146, v64, v28
    v_fmac_f32 v147, v64, v29
    v_fmac_f32 v154, v65, v28
    v_fmac_f32 v155, v65, v29
    v_lshlrev_b32 v28, 16, v98
    v_and_b32 v29, 0xffff0000, v98
    v_fmac_f32 v148, v64, v28
    v_fmac_f32 v149, v64, v29
    v_fmac_f32 v156, v65, v28
    v_fmac_f32 v157, v65, v29
    v_lshlrev_b32 v28, 16, v99
    v_and_b32 v29, 0xffff0000, v99
    v_fmac_f32 v150, v64, v28
    v_fmac_f32 v151, v64, v29
    v_fmac_f32 v158, v65, v28
    v_fmac_f32 v159, v65, v29
    v_lshlrev_b32 v28, 16, v112
    v_and_b32 v29, 0xffff0000, v112
    v_fmac_f32 v160, v64, v28
    v_fmac_f32 v161, v64, v29
    v_fmac_f32 v168, v65, v28
    v_fmac_f32 v169, v65, v29
    v_lshlrev_b32 v28, 16, v113
    v_and_b32 v29, 0xffff0000, v113
    v_fmac_f32 v162, v64, v28
    v_fmac_f32 v163, v64, v29
    v_fmac_f32 v170, v65, v28
    v_fmac_f32 v171, v65, v29
    v_lshlrev_b32 v28, 16, v114
    v_and_b32 v29, 0xffff0000, v114
    v_fmac_f32 v164, v64, v28
    v_fmac_f32 v165, v64, v29
    v_fmac_f32 v172, v65, v28
    v_fmac_f32 v173, v65, v29
    v_lshlrev_b32 v28, 16, v115
    v_and_b32 v29, 0xffff0000, v115
    v_fmac_f32 v166, v64, v28
    v_fmac_f32 v167, v64, v29
    v_fmac_f32 v174, v65, v28
    v_fmac_f32 v175, v65, v29
    v_lshlrev_b32 v28, 16, v100
    v_and_b32 v29, 0xffff0000, v100
    v_fmac_f32 v144, v66, v28
    v_fmac_f32 v145, v66, v29
    v_fmac_f32 v152, v67, v28
    v_fmac_f32 v153, v67, v29
    v_lshlrev_b32 v28, 16, v101
    v_and_b32 v29, 0xffff0000, v101
    v_fmac_f32 v146, v66, v28
    v_fmac_f32 v147, v66, v29
    v_fmac_f32 v154, v67, v28
    v_fmac_f32 v155, v67, v29
    v_lshlrev_b32 v28, 16, v102
    v_and_b32 v29, 0xffff0000, v102
    v_fmac_f32 v148, v66, v28
    v_fmac_f32 v149, v66, v29
    v_fmac_f32 v156, v67, v28
    v_fmac_f32 v157, v67, v29
    v_lshlrev_b32 v28, 16, v103
    v_and_b32 v29, 0xffff0000, v103
    v_fmac_f32 v150, v66, v28
    v_fmac_f32 v151, v66, v29
    v_fmac_f32 v158, v67, v28
    v_fmac_f32 v159, v67, v29
    v_lshlrev_b32 v28, 16, v116
    v_and_b32 v29, 0xffff0000, v116
    v_fmac_f32 v160, v66, v28
    v_fmac_f32 v161, v66, v29
    v_fmac_f32 v168, v67, v28
    v_fmac_f32 v169, v67, v29
    v_lshlrev_b32 v28, 16, v117
    v_and_b32 v29, 0xffff0000, v117
    v_fmac_f32 v162, v66, v28
    v_fmac_f32 v163, v66, v29
    v_fmac_f32 v170, v67, v28
    v_fmac_f32 v171, v67, v29
    v_lshlrev_b32 v28, 16, v118
    v_and_b32 v29, 0xffff0000, v118
    v_fmac_f32 v164, v66, v28
    v_fmac_f32 v165, v66, v29
    v_fmac_f32 v172, v67, v28
    v_fmac_f32 v173, v67, v29
    v_lshlrev_b32 v28, 16, v119
    v_and_b32 v29, 0xffff0000, v119
    v_fmac_f32 v166, v66, v28
    v_fmac_f32 v167, v66, v29
    v_fmac_f32 v174, v67, v28
    v_fmac_f32 v175, v67, v29
    v_lshlrev_b32 v28, 16, v104
    v_and_b32 v29, 0xffff0000, v104
    v_fmac_f32 v144, v68, v28
    v_fmac_f32 v145, v68, v29
    v_fmac_f32 v152, v69, v28
    v_fmac_f32 v153, v69, v29
    v_lshlrev_b32 v28, 16, v105
    v_and_b32 v29, 0xffff0000, v105
    v_fmac_f32 v146, v68, v28
    v_fmac_f32 v147, v68, v29
    v_fmac_f32 v154, v69, v28
    v_fmac_f32 v155, v69, v29
    v_lshlrev_b32 v28, 16, v106
    v_and_b32 v29, 0xffff0000, v106
    v_fmac_f32 v148, v68, v28
    v_fmac_f32 v149, v68, v29
    v_fmac_f32 v156, v69, v28
    v_fmac_f32 v157, v69, v29
    v_lshlrev_b32 v28, 16, v107
    v_and_b32 v29, 0xffff0000, v107
    v_fmac_f32 v150, v68, v28
    v_fmac_f32 v151, v68, v29
    v_fmac_f32 v158, v69, v28
    v_fmac_f32 v159, v69, v29
    v_lshlrev_b32 v28, 16, v120
    v_and_b32 v29, 0xffff0000, v120
    v_fmac_f32 v160, v68, v28
    v_fmac_f32 v161, v68, v29
    v_fmac_f32 v168, v69, v28
    v_fmac_f32 v169, v69, v29
    v_lshlrev_b32 v28, 16, v121
    v_and_b32 v29, 0xffff0000, v121
    v_fmac_f32 v162, v68, v28
    v_fmac_f32 v163, v68, v29
    v_fmac_f32 v170, v69, v28
    v_fmac_f32 v171, v69, v29
    v_lshlrev_b32 v28, 16, v122
    v_and_b32 v29, 0xffff0000, v122
    v_fmac_f32 v164, v68, v28
    v_fmac_f32 v165, v68, v29
    v_fmac_f32 v172, v69, v28
    v_fmac_f32 v173, v69, v29
    v_lshlrev_b32 v28, 16, v123
    v_and_b32 v29, 0xffff0000, v123
    v_fmac_f32 v166, v68, v28
    v_fmac_f32 v167, v68, v29
    v_fmac_f32 v174, v69, v28
    v_fmac_f32 v175, v69, v29
    v_lshlrev_b32 v28, 16, v108
    v_and_b32 v29, 0xffff0000, v108
    v_fmac_f32 v144, v70, v28
    v_fmac_f32 v145, v70, v29
    v_fmac_f32 v152, v71, v28
    v_fmac_f32 v153, v71, v29
    v_lshlrev_b32 v28, 16, v109
    v_and_b32 v29, 0xffff0000, v109
    v_fmac_f32 v146, v70, v28
    v_fmac_f32 v147, v70, v29
    v_fmac_f32 v154, v71, v28
    v_fmac_f32 v155, v71, v29
    v_lshlrev_b32 v28, 16, v110
    v_and_b32 v29, 0xffff0000, v110
    v_fmac_f32 v148, v70, v28
    v_fmac_f32 v149, v70, v29
    v_fmac_f32 v156, v71, v28
    v_fmac_f32 v157, v71, v29
    v_lshlrev_b32 v28, 16, v111
    v_and_b32 v29, 0xffff0000, v111
    v_fmac_f32 v150, v70, v28
    v_fmac_f32 v151, v70, v29
    v_fmac_f32 v158, v71, v28
    v_fmac_f32 v159, v71, v29
    v_lshlrev_b32 v28, 16, v124
    v_and_b32 v29, 0xffff0000, v124
    v_fmac_f32 v160, v70, v28
    v_fmac_f32 v161, v70, v29
    v_fmac_f32 v168, v71, v28
    v_fmac_f32 v169, v71, v29
    v_lshlrev_b32 v28, 16, v125
    v_and_b32 v29, 0xffff0000, v125
    v_fmac_f32 v162, v70, v28
    v_fmac_f32 v163, v70, v29
    v_fmac_f32 v170, v71, v28
    v_fmac_f32 v171, v71, v29
    v_lshlrev_b32 v28, 16, v126
    v_and_b32 v29, 0xffff0000, v126
    v_fmac_f32 v164, v70, v28
    v_fmac_f32 v165, v70, v29
    v_fmac_f32 v172, v71, v28
    v_fmac_f32 v173, v71, v29
    v_lshlrev_b32 v28, 16, v127
    v_and_b32 v29, 0xffff0000, v127
    v_fmac_f32 v166, v70, v28
    v_fmac_f32 v167, v70, v29
    v_fmac_f32 v174, v71, v28
    v_fmac_f32 v175, v71, v29
    s_nop 1
    v_add_f32_dpp v144, v144, v144 row_ror:2 row_mask:0xf bank_mask:0xf
    v_add_f32_dpp v145, v145, v145 row_ror:2 row_mask:0xf bank_mask:0xf
    v_add_f32_dpp v146, v146, v146 row_ror:2 row_mask:0xf bank_mask:0xf
    v_add_f32_dpp v147, v147, v147 row_ror:2 row_mask:0xf bank_mask:0xf
    v_add_f32_dpp v148, v148, v148 row_ror:2 row_mask:0xf bank_mask:0xf
    v_add_f32_dpp v149, v149, v149 row_ror:2 row_mask:0xf bank_mask:0xf
    v_add_f32_dpp v150, v150, v150 row_ror:2 row_mask:0xf bank_mask:0xf
    v_add_f32_dpp v151, v151, v151 row_ror:2 row_mask:0xf bank_mask:0xf
    v_add_f32_dpp v152, v152, v152 row_ror:2 row_mask:0xf bank_mask:0xf
    v_add_f32_dpp v153, v153, v153 row_ror:2 row_mask:0xf bank_mask:0xf
    v_add_f32_dpp v154, v154, v154 row_ror:2 row_mask:0xf bank_mask:0xf
    v_add_f32_dpp v155, v155, v155 row_ror:2 row_mask:0xf bank_mask:0xf
    v_add_f32_dpp v156, v156, v156 row_ror:2 row_mask:0xf bank_mask:0xf
    v_add_f32_dpp v157, v157, v157 row_ror:2 row_mask:0xf bank_mask:0xf
    v_add_f32_dpp v158, v158, v158 row_ror:2 row_mask:0xf bank_mask:0xf
    v_add_f32_dpp v159, v159, v159 row_ror:2 row_mask:0xf bank_mask:0xf
    v_add_f32_dpp v160, v160, v160 row_ror:2 row_mask:0xf bank_mask:0xf
    v_add_f32_dpp v161, v161, v161 row_ror:2 row_mask:0xf bank_mask:0xf
    v_add_f32_dpp v162, v162, v162 row_ror:2 row_mask:0xf bank_mask:0xf
    v_add_f32_dpp v163, v163, v163 row_ror:2 row_mask:0xf bank_mask:0xf
    v_add_f32_dpp v164, v164, v164 row_ror:2 row_mask:0xf bank_mask:0xf
    v_add_f32_dpp v165, v165, v165 row_ror:2 row_mask:0xf bank_mask:0xf
    v_add_f32_dpp v166, v166, v166 row_ror:2 row_mask:0xf bank_mask:0xf
    v_add_f32_dpp v167, v167, v167 row_ror:2 row_mask:0xf bank_mask:0xf
    v_add_f32_dpp v168, v168, v168 row_ror:2 row_mask:0xf bank_mask:0xf
    v_add_f32_dpp v169, v169, v169 row_ror:2 row_mask:0xf bank_mask:0xf
    v_add_f32_dpp v170, v170, v170 row_ror:2 row_mask:0xf bank_mask:0xf
    v_add_f32_dpp v171, v171, v171 row_ror:2 row_mask:0xf bank_mask:0xf
    v_add_f32_dpp v172, v172, v172 row_ror:2 row_mask:0xf bank_mask:0xf
    v_add_f32_dpp v173, v173, v173 row_ror:2 row_mask:0xf bank_mask:0xf
    v_add_f32_dpp v174, v174, v174 row_ror:2 row_mask:0xf bank_mask:0xf
    v_add_f32_dpp v175, v175, v175 row_ror:2 row_mask:0xf bank_mask:0xf
    s_nop 1
    v_add_f32_dpp v144, v144, v144 row_ror:4 row_mask:0xf bank_mask:0xf
    v_add_f32_dpp v145, v145, v145 row_ror:4 row_mask:0xf bank_mask:0xf
    v_add_f32_dpp v146, v146, v146 row_ror:4 row_mask:0xf bank_mask:0xf
    v_add_f32_dpp v147, v147, v147 row_ror:4 row_mask:0xf bank_mask:0xf
    v_add_f32_dpp v148, v148, v148 row_ror:4 row_mask:0xf bank_mask:0xf
    v_add_f32_dpp v149, v149, v149 row_ror:4 row_mask:0xf bank_mask:0xf
    v_add_f32_dpp v150, v150, v150 row_ror:4 row_mask:0xf bank_mask:0xf
    v_add_f32_dpp v151, v151, v151 row_ror:4 row_mask:0xf bank_mask:0xf
    v_add_f32_dpp v152, v152, v152 row_ror:4 row_mask:0xf bank_mask:0xf
    v_add_f32_dpp v153, v153, v153 row_ror:4 row_mask:0xf bank_mask:0xf
    v_add_f32_dpp v154, v154, v154 row_ror:4 row_mask:0xf bank_mask:0xf
    v_add_f32_dpp v155, v155, v155 row_ror:4 row_mask:0xf bank_mask:0xf
    v_add_f32_dpp v156, v156, v156 row_ror:4 row_mask:0xf bank_mask:0xf
    v_add_f32_dpp v157, v157, v157 row_ror:4 row_mask:0xf bank_mask:0xf
    v_add_f32_dpp v158, v158, v158 row_ror:4 row_mask:0xf bank_mask:0xf
    v_add_f32_dpp v159, v159, v159 row_ror:4 row_mask:0xf bank_mask:0xf
    v_add_f32_dpp v160, v160, v160 row_ror:4 row_mask:0xf bank_mask:0xf
    v_add_f32_dpp v161, v161, v161 row_ror:4 row_mask:0xf bank_mask:0xf
    v_add_f32_dpp v162, v162, v162 row_ror:4 row_mask:0xf bank_mask:0xf
    v_add_f32_dpp v163, v163, v163 row_ror:4 row_mask:0xf bank_mask:0xf
    v_add_f32_dpp v164, v164, v164 row_ror:4 row_mask:0xf bank_mask:0xf
    v_add_f32_dpp v165, v165, v165 row_ror:4 row_mask:0xf bank_mask:0xf
    v_add_f32_dpp v166, v166, v166 row_ror:4 row_mask:0xf bank_mask:0xf
    v_add_f32_dpp v167, v167, v167 row_ror:4 row_mask:0xf bank_mask:0xf
    v_add_f32_dpp v168, v168, v168 row_ror:4 row_mask:0xf bank_mask:0xf
    v_add_f32_dpp v169, v169, v169 row_ror:4 row_mask:0xf bank_mask:0xf
    v_add_f32_dpp v170, v170, v170 row_ror:4 row_mask:0xf bank_mask:0xf
    v_add_f32_dpp v171, v171, v171 row_ror:4 row_mask:0xf bank_mask:0xf
    v_add_f32_dpp v172, v172, v172 row_ror:4 row_mask:0xf bank_mask:0xf
    v_add_f32_dpp v173, v173, v173 row_ror:4 row_mask:0xf bank_mask:0xf
    v_add_f32_dpp v174, v174, v174 row_ror:4 row_mask:0xf bank_mask:0xf
    v_add_f32_dpp v175, v175, v175 row_ror:4 row_mask:0xf bank_mask:0xf
    s_nop 1
    v_add_f32_dpp v144, v144, v144 row_ror:8 row_mask:0xf bank_mask:0xf
    v_add_f32_dpp v145, v145, v145 row_ror:8 row_mask:0xf bank_mask:0xf
    v_add_f32_dpp v146, v146, v146 row_ror:8 row_mask:0xf bank_mask:0xf
    v_add_f32_dpp v147, v147, v147 row_ror:8 row_mask:0xf bank_mask:0xf
    v_add_f32_dpp v148, v148, v148 row_ror:8 row_mask:0xf bank_mask:0xf
    v_add_f32_dpp v149, v149, v149 row_ror:8 row_mask:0xf bank_mask:0xf
    v_add_f32_dpp v150, v150, v150 row_ror:8 row_mask:0xf bank_mask:0xf
    v_add_f32_dpp v151, v151, v151 row_ror:8 row_mask:0xf bank_mask:0xf
    v_add_f32_dpp v152, v152, v152 row_ror:8 row_mask:0xf bank_mask:0xf
    v_add_f32_dpp v153, v153, v153 row_ror:8 row_mask:0xf bank_mask:0xf
    v_add_f32_dpp v154, v154, v154 row_ror:8 row_mask:0xf bank_mask:0xf
    v_add_f32_dpp v155, v155, v155 row_ror:8 row_mask:0xf bank_mask:0xf
    v_add_f32_dpp v156, v156, v156 row_ror:8 row_mask:0xf bank_mask:0xf
    v_add_f32_dpp v157, v157, v157 row_ror:8 row_mask:0xf bank_mask:0xf
    v_add_f32_dpp v158, v158, v158 row_ror:8 row_mask:0xf bank_mask:0xf
    v_add_f32_dpp v159, v159, v159 row_ror:8 row_mask:0xf bank_mask:0xf
    v_add_f32_dpp v160, v160, v160 row_ror:8 row_mask:0xf bank_mask:0xf
    v_add_f32_dpp v161, v161, v161 row_ror:8 row_mask:0xf bank_mask:0xf
    v_add_f32_dpp v162, v162, v162 row_ror:8 row_mask:0xf bank_mask:0xf
    v_add_f32_dpp v163, v163, v163 row_ror:8 row_mask:0xf bank_mask:0xf
    v_add_f32_dpp v164, v164, v164 row_ror:8 row_mask:0xf bank_mask:0xf
    v_add_f32_dpp v165, v165, v165 row_ror:8 row_mask:0xf bank_mask:0xf
    v_add_f32_dpp v166, v166, v166 row_ror:8 row_mask:0xf bank_mask:0xf
    v_add_f32_dpp v167, v167, v167 row_ror:8 row_mask:0xf bank_mask:0xf
    v_add_f32_dpp v168, v168, v168 row_ror:8 row_mask:0xf bank_mask:0xf
    v_add_f32_dpp v169, v169, v169 row_ror:8 row_mask:0xf bank_mask:0xf
    v_add_f32_dpp v170, v170, v170 row_ror:8 row_mask:0xf bank_mask:0xf
    v_add_f32_dpp v171, v171, v171 row_ror:8 row_mask:0xf bank_mask:0xf
    v_add_f32_dpp v172, v172, v172 row_ror:8 row_mask:0xf bank_mask:0xf
    v_add_f32_dpp v173, v173, v173 row_ror:8 row_mask:0xf bank_mask:0xf
    v_add_f32_dpp v174, v174, v174 row_ror:8 row_mask:0xf bank_mask:0xf
    v_add_f32_dpp v175, v175, v175 row_ror:8 row_mask:0xf bank_mask:0xf
    v_mov_b32 v28, v144
    s_nop 1
    v_permlane16_swap_b32 v144, v28
    s_nop 1
    v_add_f32 v144, v144, v28
    v_mov_b32 v28, v145
    s_nop 1
    v_permlane16_swap_b32 v145, v28
    s_nop 1
    v_add_f32 v145, v145, v28
    v_mov_b32 v28, v146
    s_nop 1
    v_permlane16_swap_b32 v146, v28
    s_nop 1
    v_add_f32 v146, v146, v28
    v_mov_b32 v28, v147
    s_nop 1
    v_permlane16_swap_b32 v147, v28
    s_nop 1
    v_add_f32 v147, v147, v28
    v_mov_b32 v28, v148
    s_nop 1
    v_permlane16_swap_b32 v148, v28
    s_nop 1
    v_add_f32 v148, v148, v28
    v_mov_b32 v28, v149
    s_nop 1
    v_permlane16_swap_b32 v149, v28
    s_nop 1
    v_add_f32 v149, v149, v28
    v_mov_b32 v28, v150
    s_nop 1
    v_permlane16_swap_b32 v150, v28
    s_nop 1
    v_add_f32 v150, v150, v28
    v_mov_b32 v28, v151
    s_nop 1
    v_permlane16_swap_b32 v151, v28
    s_nop 1
    v_add_f32 v151, v151, v28
    v_mov_b32 v28, v152
    s_nop 1
    v_permlane16_swap_b32 v152, v28
    s_nop 1
    v_add_f32 v152, v152, v28
    v_mov_b32 v28, v153
    s_nop 1
    v_permlane16_swap_b32 v153, v28
    s_nop 1
    v_add_f32 v153, v153, v28
    v_mov_b32 v28, v154
    s_nop 1
    v_permlane16_swap_b32 v154, v28
    s_nop 1
    v_add_f32 v154, v154, v28
    v_mov_b32 v28, v155
    s_nop 1
    v_permlane16_swap_b32 v155, v28
    s_nop 1
    v_add_f32 v155, v155, v28
    v_mov_b32 v28, v156
    s_nop 1
    v_permlane16_swap_b32 v156, v28
    s_nop 1
    v_add_f32 v156, v156, v28
    v_mov_b32 v28, v157
    s_nop 1
    v_permlane16_swap_b32 v157, v28
    s_nop 1
    v_add_f32 v157, v157, v28
    v_mov_b32 v28, v158
    s_nop 1
    v_permlane16_swap_b32 v158, v28
    s_nop 1
    v_add_f32 v158, v158, v28
    v_mov_b32 v28, v159
    s_nop 1
    v_permlane16_swap_b32 v159, v28
    s_nop 1
    v_add_f32 v159, v159, v28
    v_mov_b32 v28, v160
    s_nop 1
    v_permlane16_swap_b32 v160, v28
    s_nop 1
    v_add_f32 v160, v160, v28
    v_mov_b32 v28, v161
    s_nop 1
    v_permlane16_swap_b32 v161, v28
    s_nop 1
    v_add_f32 v161, v161, v28
    v_mov_b32 v28, v162
    s_nop 1
    v_permlane16_swap_b32 v162, v28
    s_nop 1
    v_add_f32 v162, v162, v28
    v_mov_b32 v28, v163
    s_nop 1
    v_permlane16_swap_b32 v163, v28
    s_nop 1
    v_add_f32 v163, v163, v28
    v_mov_b32 v28, v164
    s_nop 1
    v_permlane16_swap_b32 v164, v28
    s_nop 1
    v_add_f32 v164, v164, v28
    v_mov_b32 v28, v165
    s_nop 1
    v_permlane16_swap_b32 v165, v28
    s_nop 1
    v_add_f32 v165, v165, v28
    v_mov_b32 v28, v166
    s_nop 1
    v_permlane16_swap_b32 v166, v28
    s_nop 1
    v_add_f32 v166, v166, v28
    v_mov_b32 v28, v167
    s_nop 1
    v_permlane16_swap_b32 v167, v28
    s_nop 1
    v_add_f32 v167, v167, v28
    v_mov_b32 v28, v168
    s_nop 1
    v_permlane16_swap_b32 v168, v28
    s_nop 1
    v_add_f32 v168, v168, v28
    v_mov_b32 v28, v169
    s_nop 1
    v_permlane16_swap_b32 v169, v28
    s_nop 1
    v_add_f32 v169, v169, v28
    v_mov_b32 v28, v170
    s_nop 1
    v_permlane16_swap_b32 v170, v28
    s_nop 1
    v_add_f32 v170, v170, v28
    v_mov_b32 v28, v171
    s_nop 1
    v_permlane16_swap_b32 v171, v28
    s_nop 1
    v_add_f32 v171, v171, v28
    v_mov_b32 v28, v172
    s_nop 1
    v_permlane16_swap_b32 v172, v28
    s_nop 1
    v_add_f32 v172, v172, v28
    v_mov_b32 v28, v173
    s_nop 1
    v_permlane16_swap_b32 v173, v28
    s_nop 1
    v_add_f32 v173, v173, v28
    v_mov_b32 v28, v174
    s_nop 1
    v_permlane16_swap_b32 v174, v28
    s_nop 1
    v_add_f32 v174, v174, v28
    v_mov_b32 v28, v175
    s_nop 1
    v_permlane16_swap_b32 v175, v28
    s_nop 1
    v_add_f32 v175, v175, v28
    v_mov_b32 v28, v144
    s_nop 1
    v_permlane32_swap_b32 v144, v28
    s_nop 1
    v_add_f32 v144, v144, v28
    v_mov_b32 v28, v145
    s_nop 1
    v_permlane32_swap_b32 v145, v28
    s_nop 1
    v_add_f32 v145, v145, v28
    v_mov_b32 v28, v146
    s_nop 1
    v_permlane32_swap_b32 v146, v28
    s_nop 1
    v_add_f32 v146, v146, v28
    v_mov_b32 v28, v147
    s_nop 1
    v_permlane32_swap_b32 v147, v28
    s_nop 1
    v_add_f32 v147, v147, v28
    v_mov_b32 v28, v148
    s_nop 1
    v_permlane32_swap_b32 v148, v28
    s_nop 1
    v_add_f32 v148, v148, v28
    v_mov_b32 v28, v149
    s_nop 1
    v_permlane32_swap_b32 v149, v28
    s_nop 1
    v_add_f32 v149, v149, v28
    v_mov_b32 v28, v150
    s_nop 1
    v_permlane32_swap_b32 v150, v28
    s_nop 1
    v_add_f32 v150, v150, v28
    v_mov_b32 v28, v151
    s_nop 1
    v_permlane32_swap_b32 v151, v28
    s_nop 1
    v_add_f32 v151, v151, v28
    v_mov_b32 v28, v152
    s_nop 1
    v_permlane32_swap_b32 v152, v28
    s_nop 1
    v_add_f32 v152, v152, v28
    v_mov_b32 v28, v153
    s_nop 1
    v_permlane32_swap_b32 v153, v28
    s_nop 1
    v_add_f32 v153, v153, v28
    v_mov_b32 v28, v154
    s_nop 1
    v_permlane32_swap_b32 v154, v28
    s_nop 1
    v_add_f32 v154, v154, v28
    v_mov_b32 v28, v155
    s_nop 1
    v_permlane32_swap_b32 v155, v28
    s_nop 1
    v_add_f32 v155, v155, v28
    v_mov_b32 v28, v156
    s_nop 1
    v_permlane32_swap_b32 v156, v28
    s_nop 1
    v_add_f32 v156, v156, v28
    v_mov_b32 v28, v157
    s_nop 1
    v_permlane32_swap_b32 v157, v28
    s_nop 1
    v_add_f32 v157, v157, v28
    v_mov_b32 v28, v158
    s_nop 1
    v_permlane32_swap_b32 v158, v28
    s_nop 1
    v_add_f32 v158, v158, v28
    v_mov_b32 v28, v159
    s_nop 1
    v_permlane32_swap_b32 v159, v28
    s_nop 1
    v_add_f32 v159, v159, v28
    v_mov_b32 v28, v160
    s_nop 1
    v_permlane32_swap_b32 v160, v28
    s_nop 1
    v_add_f32 v160, v160, v28
    v_mov_b32 v28, v161
    s_nop 1
    v_permlane32_swap_b32 v161, v28
    s_nop 1
    v_add_f32 v161, v161, v28
    v_mov_b32 v28, v162
    s_nop 1
    v_permlane32_swap_b32 v162, v28
    s_nop 1
    v_add_f32 v162, v162, v28
    v_mov_b32 v28, v163
    s_nop 1
    v_permlane32_swap_b32 v163, v28
    s_nop 1
    v_add_f32 v163, v163, v28
    v_mov_b32 v28, v164
    s_nop 1
    v_permlane32_swap_b32 v164, v28
    s_nop 1
    v_add_f32 v164, v164, v28
    v_mov_b32 v28, v165
    s_nop 1
    v_permlane32_swap_b32 v165, v28
    s_nop 1
    v_add_f32 v165, v165, v28
    v_mov_b32 v28, v166
    s_nop 1
    v_permlane32_swap_b32 v166, v28
    s_nop 1
    v_add_f32 v166, v166, v28
    v_mov_b32 v28, v167
    s_nop 1
    v_permlane32_swap_b32 v167, v28
    s_nop 1
    v_add_f32 v167, v167, v28
    v_mov_b32 v28, v168
    s_nop 1
    v_permlane32_swap_b32 v168, v28
    s_nop 1
    v_add_f32 v168, v168, v28
    v_mov_b32 v28, v169
    s_nop 1
    v_permlane32_swap_b32 v169, v28
    s_nop 1
    v_add_f32 v169, v169, v28
    v_mov_b32 v28, v170
    s_nop 1
    v_permlane32_swap_b32 v170, v28
    s_nop 1
    v_add_f32 v170, v170, v28
    v_mov_b32 v28, v171
    s_nop 1
    v_permlane32_swap_b32 v171, v28
    s_nop 1
    v_add_f32 v171, v171, v28
    v_mov_b32 v28, v172
    s_nop 1
    v_permlane32_swap_b32 v172, v28
    s_nop 1
    v_add_f32 v172, v172, v28
    v_mov_b32 v28, v173
    s_nop 1
    v_permlane32_swap_b32 v173, v28
    s_nop 1
    v_add_f32 v173, v173, v28
    v_mov_b32 v28, v174
    s_nop 1
    v_permlane32_swap_b32 v174, v28
    s_nop 1
    v_add_f32 v174, v174, v28
    v_mov_b32 v28, v175
    s_nop 1
    v_permlane32_swap_b32 v175, v28
    s_nop 1
    v_add_f32 v175, v175, v28
    v_lshlrev_b32 v27, 8, v2
    v_lshl_add_u32 v27, v3, 7, v27
    v_add_u32 v27, 4096, v27
    v_cmp_gt_u32 vcc, 2, v1
    s_and_saveexec_b64 s[14:15], vcc
    ds_write_b128 v27, v[144:147] offset:0
    ds_write_b128 v27, v[148:151] offset:16
    ds_write_b128 v27, v[152:155] offset:32
    ds_write_b128 v27, v[156:159] offset:48
    ds_write_b128 v27, v[160:163] offset:64
    ds_write_b128 v27, v[164:167] offset:80
    ds_write_b128 v27, v[168:171] offset:96
    ds_write_b128 v27, v[172:175] offset:112
    s_mov_b64 exec, s[14:15]
    s_waitcnt lgkmcnt(0)
    s_barrier
    v_cmp_gt_u32 vcc, 32, v0
    s_and_saveexec_b64 s[14:15], vcc
    v_lshrrev_b32 v24, 4, v0
    v_and_b32 v25, 15, v0
    v_lshrrev_b32 v26, 3, v25
    v_and_b32 v27, 7, v25
    v_lshlrev_b32 v28, 7, v26
    v_lshl_add_u32 v28, v24, 5, v28
    v_lshl_add_u32 v28, v27, 2, v28
    v_add_u32 v28, 4096, v28
    ds_read_b32 v30, v28 offset:0
    ds_read_b32 v34, v28 offset:64
    ds_read_b32 v31, v28 offset:256
    ds_read_b32 v35, v28 offset:320
    ds_read_b32 v32, v28 offset:512
    ds_read_b32 v36, v28 offset:576
    ds_read_b32 v33, v28 offset:768
    ds_read_b32 v37, v28 offset:832
    s_waitcnt lgkmcnt(0)
    v_add_f32 v30, v30, v31
    v_add_f32 v32, v32, v33
    v_add_f32 v30, v30, v32
    v_add_f32 v34, v34, v35
    v_add_f32 v36, v36, v37
    v_add_f32 v34, v34, v36
    v_cvt_pk_bf16_f32 v30, v30, v30
    v_lshlrev_b32 v30, 16, v30
    v_cvt_pk_bf16_f32 v34, v34, v34
    v_lshlrev_b32 v34, 16, v34
    v_mul_f32 v30, 0xbfb8aa3b, v30
    v_exp_f32 v30, v30
    s_nop 0
    v_add_f32 v30, 1.0, v30
    v_rcp_f32 v30, v30
    s_nop 0
    v_cvt_pk_bf16_f32 v30, v30, v30
    v_lshlrev_b32 v30, 16, v30
    v_mul_f32 v30, v30, v34
    v_cvt_pk_bf16_f32 v30, v30, v30
    v_lshlrev_b32 v30, 16, v30
    v_lshlrev_b32 v28, 3, v25
    v_lshl_add_u32 v28, v24, 2, v28
    ds_write_b32 v28, v30 offset:5120
    s_mov_b64 exec, s[14:15]
    s_waitcnt lgkmcnt(0)
    s_barrier
    v_mov_b32 v27, 0
    ds_read_b64 v[32:33], v27 offset:5120
    ds_read_b64 v[34:35], v27 offset:5128
    ds_read_b64 v[36:37], v27 offset:5136
    ds_read_b64 v[38:39], v27 offset:5144
    ds_read_b64 v[40:41], v27 offset:5152
    ds_read_b64 v[42:43], v27 offset:5160
    ds_read_b64 v[44:45], v27 offset:5168
    ds_read_b64 v[46:47], v27 offset:5176
    ds_read_b64 v[48:49], v27 offset:5184
    ds_read_b64 v[50:51], v27 offset:5192
    ds_read_b64 v[52:53], v27 offset:5200
    ds_read_b64 v[54:55], v27 offset:5208
    ds_read_b64 v[56:57], v27 offset:5216
    ds_read_b64 v[58:59], v27 offset:5224
    ds_read_b64 v[60:61], v27 offset:5232
    ds_read_b64 v[62:63], v27 offset:5240
    v_mov_b32 v24, 0
    v_mov_b32 v25, 0
    v_mov_b32 v26, 0
    v_mov_b32 v27, 0
    s_waitcnt lgkmcnt(0)
    v_lshlrev_b32 v28, 16, v128
    v_and_b32 v29, 0xffff0000, v128
    v_fmac_f32 v24, v32, v28
    v_fmac_f32 v25, v32, v29
    v_fmac_f32 v26, v33, v28
    v_fmac_f32 v27, v33, v29
    v_lshlrev_b32 v28, 16, v129
    v_and_b32 v29, 0xffff0000, v129
    v_fmac_f32 v24, v34, v28
    v_fmac_f32 v25, v34, v29
    v_fmac_f32 v26, v35, v28
    v_fmac_f32 v27, v35, v29
    v_lshlrev_b32 v28, 16, v130
    v_and_b32 v29, 0xffff0000, v130
    v_fmac_f32 v24, v36, v28
    v_fmac_f32 v25, v36, v29
    v_fmac_f32 v26, v37, v28
    v_fmac_f32 v27, v37, v29
    v_lshlrev_b32 v28, 16, v131
    v_and_b32 v29, 0xffff0000, v131
    v_fmac_f32 v24, v38, v28
    v_fmac_f32 v25, v38, v29
    v_fmac_f32 v26, v39, v28
    v_fmac_f32 v27, v39, v29
    v_lshlrev_b32 v28, 16, v132
    v_and_b32 v29, 0xffff0000, v132
    v_fmac_f32 v24, v40, v28
    v_fmac_f32 v25, v40, v29
    v_fmac_f32 v26, v41, v28
    v_fmac_f32 v27, v41, v29
    v_lshlrev_b32 v28, 16, v133
    v_and_b32 v29, 0xffff0000, v133
    v_fmac_f32 v24, v42, v28
    v_fmac_f32 v25, v42, v29
    v_fmac_f32 v26, v43, v28
    v_fmac_f32 v27, v43, v29
    v_lshlrev_b32 v28, 16, v134
    v_and_b32 v29, 0xffff0000, v134
    v_fmac_f32 v24, v44, v28
    v_fmac_f32 v25, v44, v29
    v_fmac_f32 v26, v45, v28
    v_fmac_f32 v27, v45, v29
    v_lshlrev_b32 v28, 16, v135
    v_and_b32 v29, 0xffff0000, v135
    v_fmac_f32 v24, v46, v28
    v_fmac_f32 v25, v46, v29
    v_fmac_f32 v26, v47, v28
    v_fmac_f32 v27, v47, v29
    v_lshlrev_b32 v28, 16, v136
    v_and_b32 v29, 0xffff0000, v136
    v_fmac_f32 v24, v48, v28
    v_fmac_f32 v25, v48, v29
    v_fmac_f32 v26, v49, v28
    v_fmac_f32 v27, v49, v29
    v_lshlrev_b32 v28, 16, v137
    v_and_b32 v29, 0xffff0000, v137
    v_fmac_f32 v24, v50, v28
    v_fmac_f32 v25, v50, v29
    v_fmac_f32 v26, v51, v28
    v_fmac_f32 v27, v51, v29
    v_lshlrev_b32 v28, 16, v138
    v_and_b32 v29, 0xffff0000, v138
    v_fmac_f32 v24, v52, v28
    v_fmac_f32 v25, v52, v29
    v_fmac_f32 v26, v53, v28
    v_fmac_f32 v27, v53, v29
    v_lshlrev_b32 v28, 16, v139
    v_and_b32 v29, 0xffff0000, v139
    v_fmac_f32 v24, v54, v28
    v_fmac_f32 v25, v54, v29
    v_fmac_f32 v26, v55, v28
    v_fmac_f32 v27, v55, v29
    v_lshlrev_b32 v28, 16, v140
    v_and_b32 v29, 0xffff0000, v140
    v_fmac_f32 v24, v56, v28
    v_fmac_f32 v25, v56, v29
    v_fmac_f32 v26, v57, v28
    v_fmac_f32 v27, v57, v29
    v_lshlrev_b32 v28, 16, v141
    v_and_b32 v29, 0xffff0000, v141
    v_fmac_f32 v24, v58, v28
    v_fmac_f32 v25, v58, v29
    v_fmac_f32 v26, v59, v28
    v_fmac_f32 v27, v59, v29
    v_lshlrev_b32 v28, 16, v142
    v_and_b32 v29, 0xffff0000, v142
    v_fmac_f32 v24, v60, v28
    v_fmac_f32 v25, v60, v29
    v_fmac_f32 v26, v61, v28
    v_fmac_f32 v27, v61, v29
    v_lshlrev_b32 v28, 16, v143
    v_and_b32 v29, 0xffff0000, v143
    v_fmac_f32 v24, v62, v28
    v_fmac_f32 v25, v62, v29
    v_fmac_f32 v26, v63, v28
    v_fmac_f32 v27, v63, v29
    s_lshl_b32 s16, s2, 12
    s_add_u32 s16, s16, 655360
    v_lshlrev_b32 v28, 3, v0
    v_add_u32 v28, s16, v28
    global_store_dwordx2 v28, v[24:25], s[8:9]
    global_store_dwordx2 v28, v[26:27], s[8:9] offset:2048
k4_mlp_kernel_end:
    s_endpgm
.globl k5_final_kernel
.p2align 8
.type k5_final_kernel,@function
k5_final_kernel:
    s_cmp_ge_u32 s2, 16
    s_cbranch_scc1 k5_final_kernel_end
    s_load_dwordx2 s[4:5], s[0:1], 0
    s_load_dwordx2 s[6:7], s[0:1], 72
    s_load_dwordx2 s[8:9], s[0:1], 88
    v_and_b32 v1, 63, v0
    v_lshrrev_b32 v2, 6, v0
    s_lshl_b32 s3, s2, 6
    v_add_u32 v3, s3, v1
    s_mov_b32 s10, 114688
    v_mul_lo_u32 v4, v2, s10
    v_lshl_add_u32 v4, v3, 2, v4
    v_add_u32 v4, 655360, v4
    v_lshlrev_b32 v5, 14, v2
    v_lshl_add_u32 v5, v3, 2, v5
    v_add_u32 v5, 589824, v5
    s_waitcnt lgkmcnt(0)
    global_load_dword v16, v4, s[8:9]
    v_add_u32 v4, 4096, v4
    global_load_dword v17, v4, s[8:9]
    v_add_u32 v4, 4096, v4
    global_load_dword v18, v4, s[8:9]
    v_add_u32 v4, 4096, v4
    global_load_dword v19, v4, s[8:9]
    v_add_u32 v4, 4096, v4
    global_load_dword v20, v4, s[8:9]
    v_add_u32 v4, 4096, v4
    global_load_dword v21, v4, s[8:9]
    v_add_u32 v4, 4096, v4
    global_load_dword v22, v4, s[8:9]
    v_add_u32 v4, 4096, v4
    global_load_dword v23, v4, s[8:9]
    v_add_u32 v4, 4096, v4
    global_load_dword v24, v4, s[8:9]
    v_add_u32 v4, 4096, v4
    global_load_dword v25, v4, s[8:9]
    v_add_u32 v4, 4096, v4
    global_load_dword v26, v4, s[8:9]
    v_add_u32 v4, 4096, v4
    global_load_dword v27, v4, s[8:9]
    v_add_u32 v4, 4096, v4
    global_load_dword v28, v4, s[8:9]
    v_add_u32 v4, 4096, v4
    global_load_dword v29, v4, s[8:9]
    v_add_u32 v4, 4096, v4
    global_load_dword v30, v4, s[8:9]
    v_add_u32 v4, 4096, v4
    global_load_dword v31, v4, s[8:9]
    v_add_u32 v4, 4096, v4
    global_load_dword v32, v4, s[8:9]
    v_add_u32 v4, 4096, v4
    global_load_dword v33, v4, s[8:9]
    v_add_u32 v4, 4096, v4
    global_load_dword v34, v4, s[8:9]
    v_add_u32 v4, 4096, v4
    global_load_dword v35, v4, s[8:9]
    v_add_u32 v4, 4096, v4
    global_load_dword v36, v4, s[8:9]
    v_add_u32 v4, 4096, v4
    global_load_dword v37, v4, s[8:9]
    v_add_u32 v4, 4096, v4
    global_load_dword v38, v4, s[8:9]
    v_add_u32 v4, 4096, v4
    global_load_dword v39, v4, s[8:9]
    v_add_u32 v4, 4096, v4
    global_load_dword v40, v4, s[8:9]
    v_add_u32 v4, 4096, v4
    global_load_dword v41, v4, s[8:9]
    v_add_u32 v4, 4096, v4
    global_load_dword v42, v4, s[8:9]
    v_add_u32 v4, 4096, v4
    global_load_dword v43, v4, s[8:9]
    v_add_u32 v4, 4096, v4
    global_load_dword v44, v5, s[8:9]
    v_add_u32 v5, 4096, v5
    global_load_dword v45, v5, s[8:9]
    v_add_u32 v5, 4096, v5
    global_load_dword v46, v5, s[8:9]
    v_add_u32 v5, 4096, v5
    global_load_dword v47, v5, s[8:9]
    v_add_u32 v5, 4096, v5
    v_lshlrev_b32 v6, 1, v3
    global_load_ushort v48, v6, s[4:5]
    s_waitcnt vmcnt(0)
    v_add_f32 v16, v16, v17
    v_add_f32 v16, v16, v18
    v_add_f32 v16, v16, v19
    v_add_f32 v16, v16, v20
    v_add_f32 v16, v16, v21
    v_add_f32 v16, v16, v22
    v_add_f32 v16, v16, v23
    v_add_f32 v16, v16, v24
    v_add_f32 v16, v16, v25
    v_add_f32 v16, v16, v26
    v_add_f32 v16, v16, v27
    v_add_f32 v16, v16, v28
    v_add_f32 v16, v16, v29
    v_add_f32 v16, v16, v30
    v_add_f32 v16, v16, v31
    v_add_f32 v16, v16, v32
    v_add_f32 v16, v16, v33
    v_add_f32 v16, v16, v34
    v_add_f32 v16, v16, v35
    v_add_f32 v16, v16, v36
    v_add_f32 v16, v16, v37
    v_add_f32 v16, v16, v38
    v_add_f32 v16, v16, v39
    v_add_f32 v16, v16, v40
    v_add_f32 v16, v16, v41
    v_add_f32 v16, v16, v42
    v_add_f32 v16, v16, v43
    v_add_f32 v44, v44, v45
    v_add_f32 v44, v44, v46
    v_add_f32 v44, v44, v47
    v_lshlrev_b32 v7, 3, v0
    v_mov_b32 v17, v44
    ds_write_b64 v7, v[16:17]
    s_waitcnt lgkmcnt(0)
    s_barrier
    v_cmp_gt_u32 vcc, 64, v0
    s_and_saveexec_b64 s[10:11], vcc
    s_cbranch_execz k5_final_kernel_end
    ds_read_b64 v[20:21], v7 offset:0
    ds_read_b64 v[22:23], v7 offset:512
    ds_read_b64 v[24:25], v7 offset:1024
    ds_read_b64 v[26:27], v7 offset:1536
    s_waitcnt lgkmcnt(0)
    v_add_f32 v20, v20, v22
    v_add_f32 v24, v24, v26
    v_add_f32 v20, v20, v24
    v_add_f32 v21, v21, v23
    v_add_f32 v25, v25, v27
    v_add_f32 v21, v21, v25
    v_cvt_pk_bf16_f32 v21, v21, v21
    v_lshlrev_b32 v21, 16, v21
    v_lshlrev_b32 v48, 16, v48
    v_add_f32 v21, v21, v48
    v_cvt_pk_bf16_f32 v21, v21, v21
    v_lshlrev_b32 v21, 16, v21
    v_cvt_pk_bf16_f32 v20, v20, v20
    v_lshlrev_b32 v20, 16, v20
    v_add_f32 v20, v20, v21
    v_cvt_pk_bf16_f32 v20, v20, v20
    global_store_short v6, v20, s[6:7]
k5_final_kernel_end:
    s_endpgm
.section .rodata,"a"
.p2align 6
.amdhsa_kernel k1_qproj_kernel
  .amdhsa_next_free_vgpr 256
  .amdhsa_next_free_sgpr 102
  .amdhsa_accum_offset 256
  .amdhsa_group_segment_fixed_size 0
  .amdhsa_kernarg_size 96
  .amdhsa_user_sgpr_count 2
  .amdhsa_user_sgpr_kernarg_segment_ptr 1
  .amdhsa_system_sgpr_workgroup_id_x 1
.end_amdhsa_kernel
.p2align 6
.amdhsa_kernel k2_attn_kernel
  .amdhsa_next_free_vgpr 256
  .amdhsa_next_free_sgpr 102
  .amdhsa_accum_offset 256
  .amdhsa_group_segment_fixed_size 0
  .amdhsa_kernarg_size 96
  .amdhsa_user_sgpr_count 2
  .amdhsa_user_sgpr_kernarg_segment_ptr 1
  .amdhsa_system_sgpr_workgroup_id_x 1
.end_amdhsa_kernel
.p2align 6
.amdhsa_kernel k3_oproj_kernel
  .amdhsa_next_free_vgpr 256
  .amdhsa_next_free_sgpr 102
  .amdhsa_accum_offset 256
  .amdhsa_group_segment_fixed_size 0
  .amdhsa_kernarg_size 96
  .amdhsa_user_sgpr_count 2
  .amdhsa_user_sgpr_kernarg_segment_ptr 1
  .amdhsa_system_sgpr_workgroup_id_x 1
.end_amdhsa_kernel
.p2align 6
.amdhsa_kernel k4_mlp_kernel
  .amdhsa_next_free_vgpr 256
  .amdhsa_next_free_sgpr 102
  .amdhsa_accum_offset 256
  .amdhsa_group_segment_fixed_size 0
  .amdhsa_kernarg_size 96
  .amdhsa_user_sgpr_count 2
  .amdhsa_user_sgpr_kernarg_segment_ptr 1
  .amdhsa_system_sgpr_workgroup_id_x 1
.end_amdhsa_kernel
.p2align 6
.amdhsa_kernel k5_final_kernel
  .amdhsa_next_free_vgpr 256
  .amdhsa_next_free_sgpr 102
  .amdhsa_accum_offset 256
  .amdhsa_group_segment_fixed_size 0
  .amdhsa_kernarg_size 96
  .amdhsa_user_sgpr_count 2
  .amdhsa_user_sgpr_kernarg_segment_ptr 1
  .amdhsa_system_sgpr_workgroup_id_x 1
.end_amdhsa_kernel
```
